```python
import torch

def _softmax(x, axis=-1):
    return torch.softmax(x, dim=axis)
def _gelu(x):
    return torch.nn.functional.gelu(x, approximate="tanh")
def _silu(x):
    return torch.nn.functional.silu(x)
def _sigmoid(x):
    return torch.sigmoid(x)
def _layernorm(x, axis=-1, eps=1e-5):
    m = x.mean(dim=axis, keepdim=True)
    v = x.var(dim=axis, keepdim=True, unbiased=False)
    return (x - m) / torch.sqrt(v + eps)
def _scatter_add(tgt, idx, src, axis=0):
    return tgt.clone().index_add_(axis, idx, src)
def _segment_sum(src, seg, n):
    out = torch.zeros((n,) + src.shape[1:], dtype=src.dtype)
    return out.index_add_(0, seg, src)
def _pad(x, pw):
    flat = tuple(v for pair in reversed(pw) for v in pair)
    return torch.nn.functional.pad(x, flat)

kernel_name = 'gather_scatter__molecular_angular_gemnet__graph'

def setup_inputs():

    _w = (lambda a: (lambda t: t.to(torch.bfloat16) if t.is_floating_point() else t)(torch.as_tensor(a)))
    N, deg, De, L = 25000, 16, 16, 2
    E = N * deg
    T = E * deg
    NR = 8
    dist = torch.rand(E).to(float)
    angle = (torch.rand(T) * torch.pi).to(float)
    centers = torch.linspace(0.0, 1.0, NR).to(float)
    ang_freq = torch.arange(1, L + 1).to(float)
    return {
        "m": _w((lambda *s: torch.randn(*s, dtype=torch.bfloat16) * 0.05)(E, De)),
        "idx_in": _w((lambda lo, hi, *s: torch.randint(lo, hi, s))(0, E, T).to(torch.int64)),
        "idx_out": _w((lambda lo, hi, *s: torch.randint(lo, hi, s))(0, E, T).to(torch.int64)),
        "dist": _w(dist),
        "angle": _w(angle),
        "centers": _w(centers),
        "ang_freq": _w(ang_freq),
        "w_rbf": _w((lambda *s: torch.randn(*s, dtype=torch.bfloat16) * 0.2)(NR, De)),
        "w_sbf": _w((lambda *s: torch.randn(*s, dtype=torch.bfloat16) * 0.2)(NR * L, De)),
        "w_down": _w((lambda *s: torch.randn(*s, dtype=torch.bfloat16) * 0.2)(De, De)),
        "w_up": _w((lambda *s: torch.randn(*s, dtype=torch.bfloat16) * 0.2)(De, De)),
    }

def reference(m, idx_in, idx_out, dist, angle, centers, ang_freq, w_rbf, w_sbf, w_down, w_up):
    E, De = m.shape[0], m.shape[1]
    NR = centers.shape[0]
    L = ang_freq.shape[0]
    rbf = torch.exp(-10.0 * (dist[:, None] - centers[None, :]) ** 2)
    cbf = torch.cos(ang_freq[None, :] * angle[:, None])
    rbf_t = rbf[idx_out]
    sbf = torch.reshape(rbf_t[:, :, None] * cbf[:, None, :], (-1, NR * L))
    x = (m[idx_in] @ w_down) * (sbf @ w_sbf)
    agg = _segment_sum(x, idx_out, E)
    return m + (agg @ w_up) * (rbf @ w_rbf)
```

```asm
; @launch kernel=gather_scatter__molecular_angular_gemnet__graph_kernel grid=(256,1,1) block=(512,1,1) lds=159872
.amdgcn_target "amdgcn-amd-amdhsa--gfx950"
.text
.globl gather_scatter__molecular_angular_gemnet__graph_kernel
.type gather_scatter__molecular_angular_gemnet__graph_kernel,@function
.p2align 8
gather_scatter__molecular_angular_gemnet__graph_kernel:
  s_cmp_ge_u32 s2, 256
  s_cbranch_scc1 L_end
  s_load_dwordx16 s[48:63], s[0:1], 0
  s_load_dwordx4 s[44:47], s[0:1], 96
  s_load_dwordx8 s[64:71], s[0:1], 64
  s_getpc_b64 s[28:29]
L_cp1:
  s_sub_u32 s28, s28, L_cp1-gather_scatter__molecular_angular_gemnet__graph_kernel
  s_subb_u32 s29, s29, 0
  s_mov_b32 s30, L_code_end-gather_scatter__molecular_angular_gemnet__graph_kernel
  s_mov_b32 s31, 0x20000
  s_and_b32 s100, s2, 0xf8
  s_lshl_b32 s100, s100, 4
  v_lshl_add_u32 v255, v0, 12, s100
  buffer_load_dword v254, v255, s[28:31], 0 offen
  v_lshlrev_b32 v250, 4, v0
  s_min_u32 s100, s2, 249
  s_mul_i32 s41, s100, 102400
  s_cmp_lt_u32 s2, 250
  s_cselect_b32 s42, 51200, 0
  s_lshl_b32 s6, s42, 1
  s_mov_b32 s10, s6
  s_mov_b32 s7, 0x20000
  s_mov_b32 s11, 0x20000
  s_mov_b32 s84, 0
  v_mov_b64 v[218:219], 0
  v_mov_b64 v[220:221], 0
  s_mov_b32 s85, 0
  ds_write_b128 v250, v[218:221]
  v_lshrrev_b32 v226, 6, v0
  s_and_b32 s32, s2, 7
  s_lshl_b32 s32, s32, 5
  s_lshr_b32 s43, s2, 3
  s_add_u32 s32, s32, s43
  v_readfirstlane_b32 s33, v226
  v_and_b32 v225, 63, v0
  v_lshlrev_b32 v224, 3, v225
  v_lshlrev_b32 v225, 2, v225
  s_mul_i32 s43, s32, 3136
  s_mul_i32 s39, s33, 400
  s_add_u32 s43, s43, s39
  s_waitcnt lgkmcnt(0)
  s_add_u32 s4, s52, s41
  s_addc_u32 s5, s53, 0
  s_add_u32 s8, s50, s41
  s_addc_u32 s9, s51, 0
  buffer_load_dwordx4 v[36:39], v250, s[4:7], s84 offen nt
  buffer_load_dwordx4 v[88:91], v250, s[8:11], s84 offen nt
  s_add_u32 s84, s84, 8192
  s_mov_b32 s28, s54
  s_mov_b32 s29, s55
  s_mov_b32 s30, 800000
  s_mov_b32 s31, 0x20000
  buffer_load_dwordx2 v[196:197], v224, s[28:31], s43 offen
  global_load_dwordx2 v[198:199], v224, s[64:65]
  global_load_dwordx2 v[200:201], v224, s[68:69]
  global_load_dwordx2 v[202:203], v224, s[66:67]
  global_load_dword v204, v225, s[62:63]
  buffer_load_dwordx4 v[40:43], v250, s[4:7], s84 offen nt
  buffer_load_dwordx4 v[92:95], v250, s[8:11], s84 offen nt
  s_add_u32 s84, s84, 8192
  s_barrier
  buffer_load_dwordx4 v[44:47], v250, s[4:7], s84 offen nt
  buffer_load_dwordx4 v[96:99], v250, s[8:11], s84 offen nt
  s_add_u32 s84, s84, 8192
  buffer_load_dwordx4 v[48:51], v250, s[4:7], s84 offen nt
  buffer_load_dwordx4 v[100:103], v250, s[8:11], s84 offen nt
  s_add_u32 s84, s84, 8192
  s_lshr_b32 s41, s41, 1
  s_add_u32 s12, s56, s41
  s_addc_u32 s13, s57, 0
  s_mov_b32 s14, s42
  s_mov_b32 s15, 0x20000
  s_add_u32 s16, s48, s41
  s_addc_u32 s17, s49, 0
  s_mov_b32 s18, s42
  s_mov_b32 s19, 0x20000
  s_mul_i32 s41, s100, 153600
  s_mul_i32 s42, s42, 3
  s_add_u32 s96, s46, s41
  s_addc_u32 s97, s47, 0
  s_mov_b32 s98, s42
  s_mov_b32 s99, 0x20000
  s_add_u32 s20, s46, 41943040
  s_addc_u32 s21, s47, 0
  s_mov_b32 s22, 2097152
  s_mov_b32 s23, 0x20000
  s_add_u32 s92, s46, 46137344
  s_addc_u32 s93, s47, 0
  s_mov_b32 s94, 4096
  s_mov_b32 s95, 0x20000
  s_mov_b32 s24, s44
  s_mov_b32 s25, s45
  s_mov_b32 s26, 256
  s_mov_b32 s27, 0x20000
  s_lshl_b32 s41, s2, 2
  v_lshl_add_u32 v240, v0, 10, s41
  s_cmp_lt_u32 s2, 250
  s_cselect_b32 s41, 0, 4
  v_mov_b32 v241, s41
  buffer_store_dword v241, v240, s[92:95], 0 offen sc1
  s_lshl_b32 s41, s41, 20
  v_or_b32 v240, s41, v240
  s_load_dword s40, s[60:61], 0
  s_load_dwordx4 s[56:59], s[58:59], 0
  v_lshlrev_b32 v233, 3, v0
  v_lshlrev_b32 v235, 2, v0
  v_lshlrev_b32 v253, 7, v0
  v_mov_b32 v237, 6
  v_mov_b32 v244, 2
  s_mov_b32 s80, 2739138
  s_mov_b32 s81, 61357
  s_mov_b32 s82, 4294965728
  s_mov_b32 s83, 0
  v_lshrrev_b32 v218, 6, v0
  v_and_b32 v220, 15, v0
  v_bfe_u32 v221, v0, 5, 1
  v_lshlrev_b32 v2, 4, v221
  v_lshl_add_u32 v28, v218, 5, v2
  v_add_u32 v28, v28, v220
  v_lshlrev_b32 v242, 13, v28
  v_and_b32 v219, 63, v0
  v_and_b32 v1, 31, v0
  v_mov_b64 v[18:19], 0
  v_mov_b32 v15, 264
  v_mov_b32 v17, 114688
  s_lshl_b32 s41, s33, 10
  s_add_u32 s41, s41, 106496
  v_lshl_add_u32 v5, v219, 4, s41
  v_bfe_u32 v224, v0, 2, 2
  v_lshlrev_b32 v4, 8, v224
  v_lshl_add_u32 v4, v221, 7, v4
  v_bfe_u32 v224, v0, 4, 1
  v_lshl_add_u32 v4, v224, 3, v4
  v_and_b32 v224, 3, v0
  v_lshl_add_u32 v4, v224, 1, v4
  v_add_u32 v4, s41, v4
  v_mov_b32 v11, 1
  v_mov_b32 v12, 0x80000000
  v_mov_b32 v16, 0x7ffffffc
  v_mul_u32_u24 v6, 6, v1
  v_add_u32 v7, 1, v1
  v_lshlrev_b32 v8, 2, v7
  v_mov_b32 v224, 25600
  v_mul_u32_u24 v28, v28, v224
  s_mul_i32 s41, s33, 6600
  s_add_u32 s41, s41, 52800
  v_lshl_add_u32 v9, v1, 3, s41
  v_lshrrev_b32 v2, 1, v2
  v_min_u32 v224, 24, v219
  v_mad_u32_u24 v10, v224, v15, s41
  v_sub_u32 v14, 511, v0
  v_cmp_eq_u32 vcc, 1, v221
  s_waitcnt lgkmcnt(0)
  s_lshl_b32 s41, s40, 16
  s_and_b32 s40, s40, 0xffff0000
  v_mov_b32 v3, s41
  v_mov_b32 v224, s40
  v_cndmask_b32 v3, v3, v224, vcc
  v_mul_f32 v3, 0.15915494, v3
  s_mov_b32 s34, -1
  s_mov_b32 s36, 0
  s_mov_b32 s37, 0
  s_mov_b32 s38, 73728
  s_mul_i32 s43, s32, 1568
  s_mul_i32 s41, s33, 200
  s_add_u32 s42, s43, 1568
  s_add_u32 s43, s43, s41
  s_add_u32 s39, s43, 200
  s_min_u32 s39, s39, s42
  s_min_u32 s39, s39, 400000
  s_lshl_b32 s39, s39, 5
  s_lshl_b32 s43, s43, 5
  s_add_u32 s3, s43, 4096
  s_cmp_ge_u32 s2, 250
  s_cbranch_scc1 L_nochunk1
  s_waitcnt vmcnt(12)
  buffer_load_dwordx4 v[52:55], v250, s[4:7], s84 offen nt
  buffer_load_dwordx4 v[104:107], v250, s[8:11], s84 offen nt
  s_add_u32 s84, s84, 8192
  v_mul_hi_u32_u24 v218, s80, v36
  v_mul_hi_u32_u24 v219, s80, v37
  v_mul_hi_u32_u24 v220, s80, v38
  v_mul_hi_u32_u24 v221, s80, v39
  v_mul_hi_u32_u24 v222, s81, v88
  v_mul_hi_u32_u24 v223, s81, v89
  v_mul_hi_u32_u24 v224, s81, v90
  v_mul_hi_u32_u24 v225, s81, v91
  v_mad_i32_i24 v226, v218, s82, v36
  v_mad_i32_i24 v227, v219, s82, v37
  v_mad_i32_i24 v228, v220, s82, v38
  v_mad_i32_i24 v229, v221, s82, v39
  v_lshl_add_u32 v36, v222, 8, v218
  v_lshl_add_u32 v37, v223, 8, v219
  v_lshl_add_u32 v38, v224, 8, v220
  v_lshl_add_u32 v39, v225, 8, v221
  v_lshlrev_b32 v36, 2, v36
  v_lshlrev_b32 v37, 2, v37
  v_lshlrev_b32 v38, 2, v38
  v_lshlrev_b32 v39, 2, v39
  ds_add_rtn_u32 v140, v36, v11
  ds_add_rtn_u32 v141, v37, v11
  ds_add_rtn_u32 v142, v38, v11
  ds_add_rtn_u32 v143, v39, v11
  v_and_b32 v218, 7, v226
  v_and_b32 v219, 7, v227
  v_and_b32 v220, 7, v228
  v_and_b32 v221, 7, v229
  v_lshl_or_b32 v88, v88, 3, v218
  v_lshl_or_b32 v89, v89, 3, v219
  v_lshl_or_b32 v90, v90, 3, v220
  v_lshl_or_b32 v91, v91, 3, v221
  v_lshrrev_b32 v226, 3, v226
  v_lshrrev_b32 v227, 3, v227
  v_lshrrev_b32 v228, 3, v228
  v_lshrrev_b32 v229, 3, v229
  v_lshl_or_b32 v88, v88, 1, v12
  v_lshl_or_b32 v89, v89, 1, v12
  v_lshl_or_b32 v90, v90, 1, v12
  v_lshl_or_b32 v91, v91, 1, v12
  v_lshl_or_b32 v88, v226, 23, v88
  v_lshl_or_b32 v89, v227, 23, v89
  v_lshl_or_b32 v90, v228, 23, v90
  v_lshl_or_b32 v91, v229, 23, v91
  s_waitcnt vmcnt(7)
  buffer_load_dwordx4 v[56:59], v250, s[4:7], s84 offen nt
  buffer_load_dwordx4 v[108:111], v250, s[8:11], s84 offen nt
  s_add_u32 s84, s84, 8192
  v_mul_hi_u32_u24 v218, s80, v40
  v_mul_hi_u32_u24 v219, s80, v41
  v_mul_hi_u32_u24 v220, s80, v42
  v_mul_hi_u32_u24 v221, s80, v43
  v_mul_hi_u32_u24 v222, s81, v92
  v_mul_hi_u32_u24 v223, s81, v93
  v_mul_hi_u32_u24 v224, s81, v94
  v_mul_hi_u32_u24 v225, s81, v95
  v_mad_i32_i24 v226, v218, s82, v40
  v_mad_i32_i24 v227, v219, s82, v41
  v_mad_i32_i24 v228, v220, s82, v42
  v_mad_i32_i24 v229, v221, s82, v43
  v_lshl_add_u32 v40, v222, 8, v218
  v_lshl_add_u32 v41, v223, 8, v219
  v_lshl_add_u32 v42, v224, 8, v220
  v_lshl_add_u32 v43, v225, 8, v221
  v_lshlrev_b32 v40, 2, v40
  v_lshlrev_b32 v41, 2, v41
  v_lshlrev_b32 v42, 2, v42
  v_lshlrev_b32 v43, 2, v43
  ds_add_rtn_u32 v144, v40, v11
  ds_add_rtn_u32 v145, v41, v11
  ds_add_rtn_u32 v146, v42, v11
  ds_add_rtn_u32 v147, v43, v11
  v_and_b32 v218, 7, v226
  v_and_b32 v219, 7, v227
  v_and_b32 v220, 7, v228
  v_and_b32 v221, 7, v229
  v_lshl_or_b32 v92, v92, 3, v218
  v_lshl_or_b32 v93, v93, 3, v219
  v_lshl_or_b32 v94, v94, 3, v220
  v_lshl_or_b32 v95, v95, 3, v221
  v_lshrrev_b32 v226, 3, v226
  v_lshrrev_b32 v227, 3, v227
  v_lshrrev_b32 v228, 3, v228
  v_lshrrev_b32 v229, 3, v229
  v_lshl_or_b32 v92, v92, 1, v12
  v_lshl_or_b32 v93, v93, 1, v12
  v_lshl_or_b32 v94, v94, 1, v12
  v_lshl_or_b32 v95, v95, 1, v12
  v_lshl_or_b32 v92, v226, 23, v92
  v_lshl_or_b32 v93, v227, 23, v93
  v_lshl_or_b32 v94, v228, 23, v94
  v_lshl_or_b32 v95, v229, 23, v95
  s_lshl_b32 s41, s33, 12
  s_add_u32 s41, s41, 8192
  v_and_b32 v169, 63, v0
  v_lshl_add_u32 v164, v169, 3, s41
  v_lshl_add_u32 v169, v169, 2, s41
  ds_write_b64 v164, v[196:197]
  ds_write_b64 v164, v[198:199] offset:512
  ds_write_b64 v164, v[200:201] offset:1024
  ds_write_b32 v169, v204 offset:1536
  ds_write_b64 v164, v[202:203] offset:2048
  v_and_b32 v165, 15, v0
  v_bfe_u32 v169, v0, 4, 2
  v_lshl_add_u32 v165, v165, 1, s41
  v_lshl_add_u32 v166, v169, 7, v165
  v_lshl_add_u32 v167, v169, 6, v165
  v_bfe_u32 v168, v0, 5, 1
  v_lshl_add_u32 v168, v168, 8, v165
  ds_read_u16 v232, v166 offset:512
  ds_read_u16 v234, v166 offset:544
  ds_read_u16 v180, v166 offset:576
  ds_read_u16 v181, v166 offset:608
  ds_read_u16 v238, v166 offset:1024
  ds_read_u16 v182, v166 offset:1056
  ds_read_u16 v239, v166 offset:1088
  ds_read_u16 v183, v166 offset:1120
  ds_read_u16 v236, v167 offset:1536
  ds_read_u16 v184, v167 offset:1568
  ds_read_u16 v248, v168 offset:2048
  ds_read_u16 v172, v168 offset:2080
  ds_read_u16 v249, v168 offset:2112
  ds_read_u16 v173, v168 offset:2144
  ds_read_u16 v251, v168 offset:2176
  ds_read_u16 v174, v168 offset:2208
  ds_read_u16 v217, v168 offset:2240
  ds_read_u16 v175, v168 offset:2272
  ds_read_u16 v26, v165 offset:0
  ds_read_u16 v27, v165 offset:32
  ds_read_u16 v29, v165 offset:64
  ds_read_u16 v30, v165 offset:96
  ds_read_u16 v31, v165 offset:128
  ds_read_u16 v32, v165 offset:160
  ds_read_u16 v33, v165 offset:192
  ds_read_u16 v34, v165 offset:224
  ds_read_u16 v35, v165 offset:256
  ds_read_u16 v86, v165 offset:288
  ds_read_u16 v87, v165 offset:320
  ds_read_u16 v190, v165 offset:352
  ds_read_u16 v191, v165 offset:384
  s_waitcnt vmcnt(7)
  buffer_load_dwordx4 v[60:63], v250, s[4:7], s84 offen nt
  buffer_load_dwordx4 v[112:115], v250, s[8:11], s84 offen nt
  s_add_u32 s84, s84, 8192
  v_mul_hi_u32_u24 v218, s80, v44
  v_mul_hi_u32_u24 v219, s80, v45
  v_mul_hi_u32_u24 v220, s80, v46
  v_mul_hi_u32_u24 v221, s80, v47
  v_mul_hi_u32_u24 v222, s81, v96
  v_mul_hi_u32_u24 v223, s81, v97
  v_mul_hi_u32_u24 v224, s81, v98
  v_mul_hi_u32_u24 v225, s81, v99
  v_mad_i32_i24 v226, v218, s82, v44
  v_mad_i32_i24 v227, v219, s82, v45
  v_mad_i32_i24 v228, v220, s82, v46
  v_mad_i32_i24 v229, v221, s82, v47
  v_lshl_add_u32 v44, v222, 8, v218
  v_lshl_add_u32 v45, v223, 8, v219
  v_lshl_add_u32 v46, v224, 8, v220
  v_lshl_add_u32 v47, v225, 8, v221
  v_lshlrev_b32 v44, 2, v44
  v_lshlrev_b32 v45, 2, v45
  v_lshlrev_b32 v46, 2, v46
  v_lshlrev_b32 v47, 2, v47
  ds_add_rtn_u32 v148, v44, v11
  ds_add_rtn_u32 v149, v45, v11
  ds_add_rtn_u32 v150, v46, v11
  ds_add_rtn_u32 v151, v47, v11
  v_and_b32 v218, 7, v226
  v_and_b32 v219, 7, v227
  v_and_b32 v220, 7, v228
  v_and_b32 v221, 7, v229
  v_lshl_or_b32 v96, v96, 3, v218
  v_lshl_or_b32 v97, v97, 3, v219
  v_lshl_or_b32 v98, v98, 3, v220
  v_lshl_or_b32 v99, v99, 3, v221
  v_lshrrev_b32 v226, 3, v226
  v_lshrrev_b32 v227, 3, v227
  v_lshrrev_b32 v228, 3, v228
  v_lshrrev_b32 v229, 3, v229
  v_lshl_or_b32 v96, v96, 1, v12
  v_lshl_or_b32 v97, v97, 1, v12
  v_lshl_or_b32 v98, v98, 1, v12
  v_lshl_or_b32 v99, v99, 1, v12
  v_lshl_or_b32 v96, v226, 23, v96
  v_lshl_or_b32 v97, v227, 23, v97
  v_lshl_or_b32 v98, v228, 23, v98
  v_lshl_or_b32 v99, v229, 23, v99
  v_mov_b32 v171, s56
  v_cmp_eq_u32 vcc, 1, v169
  v_mov_b32 v170, s57
  v_cmp_eq_u32 s[76:77], 2, v169
  v_cndmask_b32 v171, v171, v170, vcc
  v_mov_b32 v170, s58
  v_cmp_eq_u32 vcc, 3, v169
  v_cndmask_b32 v171, v171, v170, s[76:77]
  v_mov_b32 v170, s59
  v_cndmask_b32 v171, v171, v170, vcc
  v_lshlrev_b32 v170, 16, v171
  v_and_b32 v171, 0xffff0000, v171
  s_mov_b32 s56, 0xc1200000
  s_mov_b32 s57, 0xc1200000
  s_mov_b32 s58, 0x3fb8aa3b
  s_mov_b32 s59, 0x3fb8aa3b
  s_waitcnt lgkmcnt(0)
  v_lshl_or_b32 v232, v180, 16, v232
  v_lshl_or_b32 v234, v181, 16, v234
  v_lshl_or_b32 v238, v182, 16, v238
  v_lshl_or_b32 v239, v183, 16, v239
  v_lshl_or_b32 v236, v184, 16, v236
  v_lshl_or_b32 v248, v172, 16, v248
  v_lshl_or_b32 v249, v173, 16, v249
  v_lshl_or_b32 v251, v174, 16, v251
  v_lshl_or_b32 v217, v175, 16, v217
  v_lshlrev_b32 v172, 16, v26
  v_lshlrev_b32 v174, 16, v27
  v_lshlrev_b32 v176, 16, v29
  v_pk_add_f32 v[172:173], v[172:173], v[170:171] op_sel_hi:[0,1] neg_lo:[0,1] neg_hi:[0,1]
  v_pk_add_f32 v[174:175], v[174:175], v[170:171] op_sel_hi:[0,1] neg_lo:[0,1] neg_hi:[0,1]
  v_pk_add_f32 v[176:177], v[176:177], v[170:171] op_sel_hi:[0,1] neg_lo:[0,1] neg_hi:[0,1]
  v_cvt_pk_bf16_f32 v172, 0, v172
  v_cvt_pk_bf16_f32 v173, 0, v173
  v_cvt_pk_bf16_f32 v174, 0, v174
  v_cvt_pk_bf16_f32 v175, 0, v175
  v_cvt_pk_bf16_f32 v176, 0, v176
  v_cvt_pk_bf16_f32 v177, 0, v177
  v_pk_mul_f32 v[172:173], v[172:173], v[172:173]
  v_pk_mul_f32 v[174:175], v[174:175], v[174:175]
  v_pk_mul_f32 v[176:177], v[176:177], v[176:177]
  v_cvt_pk_bf16_f32 v172, 0, v172
  v_cvt_pk_bf16_f32 v173, 0, v173
  v_cvt_pk_bf16_f32 v174, 0, v174
  v_cvt_pk_bf16_f32 v175, 0, v175
  v_cvt_pk_bf16_f32 v176, 0, v176
  v_cvt_pk_bf16_f32 v177, 0, v177
  v_pk_mul_f32 v[172:173], v[172:173], s[56:57]
  v_pk_mul_f32 v[174:175], v[174:175], s[56:57]
  v_pk_mul_f32 v[176:177], v[176:177], s[56:57]
  v_cvt_pk_bf16_f32 v172, 0, v172
  v_cvt_pk_bf16_f32 v173, 0, v173
  v_cvt_pk_bf16_f32 v174, 0, v174
  v_cvt_pk_bf16_f32 v175, 0, v175
  v_cvt_pk_bf16_f32 v176, 0, v176
  v_cvt_pk_bf16_f32 v177, 0, v177
  v_pk_mul_f32 v[172:173], v[172:173], s[58:59]
  v_pk_mul_f32 v[174:175], v[174:175], s[58:59]
  v_pk_mul_f32 v[176:177], v[176:177], s[58:59]
  v_exp_f32 v172, v172
  v_exp_f32 v173, v173
  v_exp_f32 v174, v174
  v_exp_f32 v175, v175
  v_exp_f32 v176, v176
  v_exp_f32 v177, v177
  v_cvt_pk_bf16_f32 v26, v172, v173
  v_cvt_pk_bf16_f32 v27, v174, v175
  v_cvt_pk_bf16_f32 v29, v176, v177
  s_waitcnt vmcnt(7)
  buffer_load_dwordx4 v[64:67], v250, s[4:7], s84 offen nt
  buffer_load_dwordx4 v[116:119], v250, s[8:11], s84 offen nt
  s_add_u32 s84, s84, 8192
  v_mul_hi_u32_u24 v218, s80, v48
  v_mul_hi_u32_u24 v219, s80, v49
  v_mul_hi_u32_u24 v220, s80, v50
  v_mul_hi_u32_u24 v221, s80, v51
  v_mul_hi_u32_u24 v222, s81, v100
  v_mul_hi_u32_u24 v223, s81, v101
  v_mul_hi_u32_u24 v224, s81, v102
  v_mul_hi_u32_u24 v225, s81, v103
  v_mad_i32_i24 v226, v218, s82, v48
  v_mad_i32_i24 v227, v219, s82, v49
  v_mad_i32_i24 v228, v220, s82, v50
  v_mad_i32_i24 v229, v221, s82, v51
  v_lshl_add_u32 v48, v222, 8, v218
  v_lshl_add_u32 v49, v223, 8, v219
  v_lshl_add_u32 v50, v224, 8, v220
  v_lshl_add_u32 v51, v225, 8, v221
  v_lshlrev_b32 v48, 2, v48
  v_lshlrev_b32 v49, 2, v49
  v_lshlrev_b32 v50, 2, v50
  v_lshlrev_b32 v51, 2, v51
  ds_add_rtn_u32 v152, v48, v11
  ds_add_rtn_u32 v153, v49, v11
  ds_add_rtn_u32 v154, v50, v11
  ds_add_rtn_u32 v155, v51, v11
  v_and_b32 v218, 7, v226
  v_and_b32 v219, 7, v227
  v_and_b32 v220, 7, v228
  v_and_b32 v221, 7, v229
  v_lshl_or_b32 v100, v100, 3, v218
  v_lshl_or_b32 v101, v101, 3, v219
  v_lshl_or_b32 v102, v102, 3, v220
  v_lshl_or_b32 v103, v103, 3, v221
  v_lshrrev_b32 v226, 3, v226
  v_lshrrev_b32 v227, 3, v227
  v_lshrrev_b32 v228, 3, v228
  v_lshrrev_b32 v229, 3, v229
  v_lshl_or_b32 v100, v100, 1, v12
  v_lshl_or_b32 v101, v101, 1, v12
  v_lshl_or_b32 v102, v102, 1, v12
  v_lshl_or_b32 v103, v103, 1, v12
  v_lshl_or_b32 v100, v226, 23, v100
  v_lshl_or_b32 v101, v227, 23, v101
  v_lshl_or_b32 v102, v228, 23, v102
  v_lshl_or_b32 v103, v229, 23, v103
  v_lshlrev_b32 v172, 16, v30
  v_lshlrev_b32 v174, 16, v31
  v_lshlrev_b32 v176, 16, v32
  v_lshlrev_b32 v178, 16, v33
  v_lshlrev_b32 v180, 16, v34
  v_pk_add_f32 v[172:173], v[172:173], v[170:171] op_sel_hi:[0,1] neg_lo:[0,1] neg_hi:[0,1]
  v_pk_add_f32 v[174:175], v[174:175], v[170:171] op_sel_hi:[0,1] neg_lo:[0,1] neg_hi:[0,1]
  v_pk_add_f32 v[176:177], v[176:177], v[170:171] op_sel_hi:[0,1] neg_lo:[0,1] neg_hi:[0,1]
  v_pk_add_f32 v[178:179], v[178:179], v[170:171] op_sel_hi:[0,1] neg_lo:[0,1] neg_hi:[0,1]
  v_pk_add_f32 v[180:181], v[180:181], v[170:171] op_sel_hi:[0,1] neg_lo:[0,1] neg_hi:[0,1]
  v_cvt_pk_bf16_f32 v172, 0, v172
  v_cvt_pk_bf16_f32 v173, 0, v173
  v_cvt_pk_bf16_f32 v174, 0, v174
  v_cvt_pk_bf16_f32 v175, 0, v175
  v_cvt_pk_bf16_f32 v176, 0, v176
  v_cvt_pk_bf16_f32 v177, 0, v177
  v_cvt_pk_bf16_f32 v178, 0, v178
  v_cvt_pk_bf16_f32 v179, 0, v179
  v_cvt_pk_bf16_f32 v180, 0, v180
  v_cvt_pk_bf16_f32 v181, 0, v181
  v_pk_mul_f32 v[172:173], v[172:173], v[172:173]
  v_pk_mul_f32 v[174:175], v[174:175], v[174:175]
  v_pk_mul_f32 v[176:177], v[176:177], v[176:177]
  v_pk_mul_f32 v[178:179], v[178:179], v[178:179]
  v_pk_mul_f32 v[180:181], v[180:181], v[180:181]
  v_cvt_pk_bf16_f32 v172, 0, v172
  v_cvt_pk_bf16_f32 v173, 0, v173
  v_cvt_pk_bf16_f32 v174, 0, v174
  v_cvt_pk_bf16_f32 v175, 0, v175
  v_cvt_pk_bf16_f32 v176, 0, v176
  v_cvt_pk_bf16_f32 v177, 0, v177
  v_cvt_pk_bf16_f32 v178, 0, v178
  v_cvt_pk_bf16_f32 v179, 0, v179
  v_cvt_pk_bf16_f32 v180, 0, v180
  v_cvt_pk_bf16_f32 v181, 0, v181
  v_pk_mul_f32 v[172:173], v[172:173], s[56:57]
  v_pk_mul_f32 v[174:175], v[174:175], s[56:57]
  v_pk_mul_f32 v[176:177], v[176:177], s[56:57]
  v_pk_mul_f32 v[178:179], v[178:179], s[56:57]
  v_pk_mul_f32 v[180:181], v[180:181], s[56:57]
  v_cvt_pk_bf16_f32 v172, 0, v172
  v_cvt_pk_bf16_f32 v173, 0, v173
  v_cvt_pk_bf16_f32 v174, 0, v174
  v_cvt_pk_bf16_f32 v175, 0, v175
  v_cvt_pk_bf16_f32 v176, 0, v176
  v_cvt_pk_bf16_f32 v177, 0, v177
  v_cvt_pk_bf16_f32 v178, 0, v178
  v_cvt_pk_bf16_f32 v179, 0, v179
  v_cvt_pk_bf16_f32 v180, 0, v180
  v_cvt_pk_bf16_f32 v181, 0, v181
  v_pk_mul_f32 v[172:173], v[172:173], s[58:59]
  v_pk_mul_f32 v[174:175], v[174:175], s[58:59]
  v_pk_mul_f32 v[176:177], v[176:177], s[58:59]
  v_pk_mul_f32 v[178:179], v[178:179], s[58:59]
  v_pk_mul_f32 v[180:181], v[180:181], s[58:59]
  v_exp_f32 v172, v172
  v_exp_f32 v173, v173
  v_exp_f32 v174, v174
  v_exp_f32 v175, v175
  v_exp_f32 v176, v176
  v_exp_f32 v177, v177
  v_exp_f32 v178, v178
  v_exp_f32 v179, v179
  v_exp_f32 v180, v180
  v_exp_f32 v181, v181
  v_cvt_pk_bf16_f32 v30, v172, v173
  v_cvt_pk_bf16_f32 v31, v174, v175
  v_cvt_pk_bf16_f32 v32, v176, v177
  v_cvt_pk_bf16_f32 v33, v178, v179
  v_cvt_pk_bf16_f32 v34, v180, v181
  s_waitcnt vmcnt(6)
  s_and_b32 s100, s2, 15
  s_lshl_b32 s100, s100, 4
  v_lshlrev_b32 v218, 8, v0
  buffer_atomic_add v11, v218, s[24:27], s100 offen
  buffer_load_dwordx4 v[68:71], v250, s[4:7], s84 offen nt
  buffer_load_dwordx4 v[120:123], v250, s[8:11], s84 offen nt
  s_add_u32 s84, s84, 8192
  v_mul_hi_u32_u24 v218, s80, v52
  v_mul_hi_u32_u24 v219, s80, v53
  v_mul_hi_u32_u24 v220, s80, v54
  v_mul_hi_u32_u24 v221, s80, v55
  v_mul_hi_u32_u24 v222, s81, v104
  v_mul_hi_u32_u24 v223, s81, v105
  v_mul_hi_u32_u24 v224, s81, v106
  v_mul_hi_u32_u24 v225, s81, v107
  v_mad_i32_i24 v226, v218, s82, v52
  v_mad_i32_i24 v227, v219, s82, v53
  v_mad_i32_i24 v228, v220, s82, v54
  v_mad_i32_i24 v229, v221, s82, v55
  v_lshl_add_u32 v52, v222, 8, v218
  v_lshl_add_u32 v53, v223, 8, v219
  v_lshl_add_u32 v54, v224, 8, v220
  v_lshl_add_u32 v55, v225, 8, v221
  v_lshlrev_b32 v52, 2, v52
  v_lshlrev_b32 v53, 2, v53
  v_lshlrev_b32 v54, 2, v54
  v_lshlrev_b32 v55, 2, v55
  ds_add_rtn_u32 v156, v52, v11
  ds_add_rtn_u32 v157, v53, v11
  ds_add_rtn_u32 v158, v54, v11
  ds_add_rtn_u32 v159, v55, v11
  v_and_b32 v218, 7, v226
  v_and_b32 v219, 7, v227
  v_and_b32 v220, 7, v228
  v_and_b32 v221, 7, v229
  v_lshl_or_b32 v104, v104, 3, v218
  v_lshl_or_b32 v105, v105, 3, v219
  v_lshl_or_b32 v106, v106, 3, v220
  v_lshl_or_b32 v107, v107, 3, v221
  v_lshrrev_b32 v226, 3, v226
  v_lshrrev_b32 v227, 3, v227
  v_lshrrev_b32 v228, 3, v228
  v_lshrrev_b32 v229, 3, v229
  v_lshl_or_b32 v104, v104, 1, v12
  v_lshl_or_b32 v105, v105, 1, v12
  v_lshl_or_b32 v106, v106, 1, v12
  v_lshl_or_b32 v107, v107, 1, v12
  v_lshl_or_b32 v104, v226, 23, v104
  v_lshl_or_b32 v105, v227, 23, v105
  v_lshl_or_b32 v106, v228, 23, v106
  v_lshl_or_b32 v107, v229, 23, v107
  v_lshlrev_b32 v172, 16, v35
  v_lshlrev_b32 v174, 16, v86
  v_lshlrev_b32 v176, 16, v87
  v_lshlrev_b32 v178, 16, v190
  v_lshlrev_b32 v180, 16, v191
  v_pk_add_f32 v[172:173], v[172:173], v[170:171] op_sel_hi:[0,1] neg_lo:[0,1] neg_hi:[0,1]
  v_pk_add_f32 v[174:175], v[174:175], v[170:171] op_sel_hi:[0,1] neg_lo:[0,1] neg_hi:[0,1]
  v_pk_add_f32 v[176:177], v[176:177], v[170:171] op_sel_hi:[0,1] neg_lo:[0,1] neg_hi:[0,1]
  v_pk_add_f32 v[178:179], v[178:179], v[170:171] op_sel_hi:[0,1] neg_lo:[0,1] neg_hi:[0,1]
  v_pk_add_f32 v[180:181], v[180:181], v[170:171] op_sel_hi:[0,1] neg_lo:[0,1] neg_hi:[0,1]
  v_cvt_pk_bf16_f32 v172, 0, v172
  v_cvt_pk_bf16_f32 v173, 0, v173
  v_cvt_pk_bf16_f32 v174, 0, v174
  v_cvt_pk_bf16_f32 v175, 0, v175
  v_cvt_pk_bf16_f32 v176, 0, v176
  v_cvt_pk_bf16_f32 v177, 0, v177
  v_cvt_pk_bf16_f32 v178, 0, v178
  v_cvt_pk_bf16_f32 v179, 0, v179
  v_cvt_pk_bf16_f32 v180, 0, v180
  v_cvt_pk_bf16_f32 v181, 0, v181
  v_pk_mul_f32 v[172:173], v[172:173], v[172:173]
  v_pk_mul_f32 v[174:175], v[174:175], v[174:175]
  v_pk_mul_f32 v[176:177], v[176:177], v[176:177]
  v_pk_mul_f32 v[178:179], v[178:179], v[178:179]
  v_pk_mul_f32 v[180:181], v[180:181], v[180:181]
  v_cvt_pk_bf16_f32 v172, 0, v172
  v_cvt_pk_bf16_f32 v173, 0, v173
  v_cvt_pk_bf16_f32 v174, 0, v174
  v_cvt_pk_bf16_f32 v175, 0, v175
  v_cvt_pk_bf16_f32 v176, 0, v176
  v_cvt_pk_bf16_f32 v177, 0, v177
  v_cvt_pk_bf16_f32 v178, 0, v178
  v_cvt_pk_bf16_f32 v179, 0, v179
  v_cvt_pk_bf16_f32 v180, 0, v180
  v_cvt_pk_bf16_f32 v181, 0, v181
  v_pk_mul_f32 v[172:173], v[172:173], s[56:57]
  v_pk_mul_f32 v[174:175], v[174:175], s[56:57]
  v_pk_mul_f32 v[176:177], v[176:177], s[56:57]
  v_pk_mul_f32 v[178:179], v[178:179], s[56:57]
  v_pk_mul_f32 v[180:181], v[180:181], s[56:57]
  v_cvt_pk_bf16_f32 v172, 0, v172
  v_cvt_pk_bf16_f32 v173, 0, v173
  v_cvt_pk_bf16_f32 v174, 0, v174
  v_cvt_pk_bf16_f32 v175, 0, v175
  v_cvt_pk_bf16_f32 v176, 0, v176
  v_cvt_pk_bf16_f32 v177, 0, v177
  v_cvt_pk_bf16_f32 v178, 0, v178
  v_cvt_pk_bf16_f32 v179, 0, v179
  v_cvt_pk_bf16_f32 v180, 0, v180
  v_cvt_pk_bf16_f32 v181, 0, v181
  v_pk_mul_f32 v[172:173], v[172:173], s[58:59]
  v_pk_mul_f32 v[174:175], v[174:175], s[58:59]
  v_pk_mul_f32 v[176:177], v[176:177], s[58:59]
  v_pk_mul_f32 v[178:179], v[178:179], s[58:59]
  v_pk_mul_f32 v[180:181], v[180:181], s[58:59]
  v_exp_f32 v172, v172
  v_exp_f32 v173, v173
  v_exp_f32 v174, v174
  v_exp_f32 v175, v175
  v_exp_f32 v176, v176
  v_exp_f32 v177, v177
  v_exp_f32 v178, v178
  v_exp_f32 v179, v179
  v_exp_f32 v180, v180
  v_exp_f32 v181, v181
  v_cvt_pk_bf16_f32 v35, v172, v173
  v_cvt_pk_bf16_f32 v86, v174, v175
  v_cvt_pk_bf16_f32 v87, v176, v177
  v_cvt_pk_bf16_f32 v190, v178, v179
  v_cvt_pk_bf16_f32 v191, v180, v181
  s_waitcnt vmcnt(7)
  buffer_load_dwordx4 v[72:75], v250, s[4:7], s84 offen nt
  buffer_load_dwordx4 v[124:127], v250, s[8:11], s84 offen nt
  s_add_u32 s84, s84, 8192
  v_mul_hi_u32_u24 v218, s80, v56
  v_mul_hi_u32_u24 v219, s80, v57
  v_mul_hi_u32_u24 v220, s80, v58
  v_mul_hi_u32_u24 v221, s80, v59
  v_mul_hi_u32_u24 v222, s81, v108
  v_mul_hi_u32_u24 v223, s81, v109
  v_mul_hi_u32_u24 v224, s81, v110
  v_mul_hi_u32_u24 v225, s81, v111
  v_mad_i32_i24 v226, v218, s82, v56
  v_mad_i32_i24 v227, v219, s82, v57
  v_mad_i32_i24 v228, v220, s82, v58
  v_mad_i32_i24 v229, v221, s82, v59
  v_lshl_add_u32 v56, v222, 8, v218
  v_lshl_add_u32 v57, v223, 8, v219
  v_lshl_add_u32 v58, v224, 8, v220
  v_lshl_add_u32 v59, v225, 8, v221
  v_lshlrev_b32 v56, 2, v56
  v_lshlrev_b32 v57, 2, v57
  v_lshlrev_b32 v58, 2, v58
  v_lshlrev_b32 v59, 2, v59
  ds_add_rtn_u32 v160, v56, v11
  ds_add_rtn_u32 v161, v57, v11
  ds_add_rtn_u32 v162, v58, v11
  ds_add_rtn_u32 v163, v59, v11
  v_and_b32 v218, 7, v226
  v_and_b32 v219, 7, v227
  v_and_b32 v220, 7, v228
  v_and_b32 v221, 7, v229
  v_lshl_or_b32 v108, v108, 3, v218
  v_lshl_or_b32 v109, v109, 3, v219
  v_lshl_or_b32 v110, v110, 3, v220
  v_lshl_or_b32 v111, v111, 3, v221
  v_lshrrev_b32 v226, 3, v226
  v_lshrrev_b32 v227, 3, v227
  v_lshrrev_b32 v228, 3, v228
  v_lshrrev_b32 v229, 3, v229
  v_lshl_or_b32 v108, v108, 1, v12
  v_lshl_or_b32 v109, v109, 1, v12
  v_lshl_or_b32 v110, v110, 1, v12
  v_lshl_or_b32 v111, v111, 1, v12
  v_lshl_or_b32 v108, v226, 23, v108
  v_lshl_or_b32 v109, v227, 23, v109
  v_lshl_or_b32 v110, v228, 23, v110
  v_lshl_or_b32 v111, v229, 23, v111
  s_waitcnt vmcnt(7)
  buffer_load_dwordx4 v[76:79], v250, s[4:7], s84 offen nt
  buffer_load_dwordx4 v[128:131], v250, s[8:11], s84 offen nt
  s_add_u32 s84, s84, 8192
  v_mul_hi_u32_u24 v218, s80, v60
  v_mul_hi_u32_u24 v219, s80, v61
  v_mul_hi_u32_u24 v220, s80, v62
  v_mul_hi_u32_u24 v221, s80, v63
  v_mul_hi_u32_u24 v222, s81, v112
  v_mul_hi_u32_u24 v223, s81, v113
  v_mul_hi_u32_u24 v224, s81, v114
  v_mul_hi_u32_u24 v225, s81, v115
  v_mad_i32_i24 v226, v218, s82, v60
  v_mad_i32_i24 v227, v219, s82, v61
  v_mad_i32_i24 v228, v220, s82, v62
  v_mad_i32_i24 v229, v221, s82, v63
  v_lshl_add_u32 v60, v222, 8, v218
  v_lshl_add_u32 v61, v223, 8, v219
  v_lshl_add_u32 v62, v224, 8, v220
  v_lshl_add_u32 v63, v225, 8, v221
  v_lshlrev_b32 v60, 2, v60
  v_lshlrev_b32 v61, 2, v61
  v_lshlrev_b32 v62, 2, v62
  v_lshlrev_b32 v63, 2, v63
  ds_add_rtn_u32 v164, v60, v11
  ds_add_rtn_u32 v165, v61, v11
  ds_add_rtn_u32 v166, v62, v11
  ds_add_rtn_u32 v167, v63, v11
  v_and_b32 v218, 7, v226
  v_and_b32 v219, 7, v227
  v_and_b32 v220, 7, v228
  v_and_b32 v221, 7, v229
  v_lshl_or_b32 v112, v112, 3, v218
  v_lshl_or_b32 v113, v113, 3, v219
  v_lshl_or_b32 v114, v114, 3, v220
  v_lshl_or_b32 v115, v115, 3, v221
  v_lshrrev_b32 v226, 3, v226
  v_lshrrev_b32 v227, 3, v227
  v_lshrrev_b32 v228, 3, v228
  v_lshrrev_b32 v229, 3, v229
  v_lshl_or_b32 v112, v112, 1, v12
  v_lshl_or_b32 v113, v113, 1, v12
  v_lshl_or_b32 v114, v114, 1, v12
  v_lshl_or_b32 v115, v115, 1, v12
  v_lshl_or_b32 v112, v226, 23, v112
  v_lshl_or_b32 v113, v227, 23, v113
  v_lshl_or_b32 v114, v228, 23, v114
  v_lshl_or_b32 v115, v229, 23, v115
  s_waitcnt vmcnt(7)
  buffer_load_dwordx4 v[80:83], v250, s[4:7], s84 offen nt
  buffer_load_dwordx4 v[132:135], v250, s[8:11], s84 offen nt
  s_add_u32 s84, s84, 8192
  v_mul_hi_u32_u24 v218, s80, v64
  v_mul_hi_u32_u24 v219, s80, v65
  v_mul_hi_u32_u24 v220, s80, v66
  v_mul_hi_u32_u24 v221, s80, v67
  v_mul_hi_u32_u24 v222, s81, v116
  v_mul_hi_u32_u24 v223, s81, v117
  v_mul_hi_u32_u24 v224, s81, v118
  v_mul_hi_u32_u24 v225, s81, v119
  v_mad_i32_i24 v226, v218, s82, v64
  v_mad_i32_i24 v227, v219, s82, v65
  v_mad_i32_i24 v228, v220, s82, v66
  v_mad_i32_i24 v229, v221, s82, v67
  v_lshl_add_u32 v64, v222, 8, v218
  v_lshl_add_u32 v65, v223, 8, v219
  v_lshl_add_u32 v66, v224, 8, v220
  v_lshl_add_u32 v67, v225, 8, v221
  v_lshlrev_b32 v64, 2, v64
  v_lshlrev_b32 v65, 2, v65
  v_lshlrev_b32 v66, 2, v66
  v_lshlrev_b32 v67, 2, v67
  ds_add_rtn_u32 v168, v64, v11
  ds_add_rtn_u32 v169, v65, v11
  ds_add_rtn_u32 v170, v66, v11
  ds_add_rtn_u32 v171, v67, v11
  v_and_b32 v218, 7, v226
  v_and_b32 v219, 7, v227
  v_and_b32 v220, 7, v228
  v_and_b32 v221, 7, v229
  v_lshl_or_b32 v116, v116, 3, v218
  v_lshl_or_b32 v117, v117, 3, v219
  v_lshl_or_b32 v118, v118, 3, v220
  v_lshl_or_b32 v119, v119, 3, v221
  v_lshrrev_b32 v226, 3, v226
  v_lshrrev_b32 v227, 3, v227
  v_lshrrev_b32 v228, 3, v228
  v_lshrrev_b32 v229, 3, v229
  v_lshl_or_b32 v116, v116, 1, v12
  v_lshl_or_b32 v117, v117, 1, v12
  v_lshl_or_b32 v118, v118, 1, v12
  v_lshl_or_b32 v119, v119, 1, v12
  v_lshl_or_b32 v116, v226, 23, v116
  v_lshl_or_b32 v117, v227, 23, v117
  v_lshl_or_b32 v118, v228, 23, v118
  v_lshl_or_b32 v119, v229, 23, v119
  s_waitcnt vmcnt(6)
  buffer_load_dwordx2 v[84:85], v233, s[4:7], s84 offen nt
  buffer_load_dwordx2 v[136:137], v233, s[8:11], s84 offen nt
  v_mul_hi_u32_u24 v218, s80, v68
  v_mul_hi_u32_u24 v219, s80, v69
  v_mul_hi_u32_u24 v220, s80, v70
  v_mul_hi_u32_u24 v221, s80, v71
  v_mul_hi_u32_u24 v222, s81, v120
  v_mul_hi_u32_u24 v223, s81, v121
  v_mul_hi_u32_u24 v224, s81, v122
  v_mul_hi_u32_u24 v225, s81, v123
  v_mad_i32_i24 v226, v218, s82, v68
  v_mad_i32_i24 v227, v219, s82, v69
  v_mad_i32_i24 v228, v220, s82, v70
  v_mad_i32_i24 v229, v221, s82, v71
  v_lshl_add_u32 v68, v222, 8, v218
  v_lshl_add_u32 v69, v223, 8, v219
  v_lshl_add_u32 v70, v224, 8, v220
  v_lshl_add_u32 v71, v225, 8, v221
  v_lshlrev_b32 v68, 2, v68
  v_lshlrev_b32 v69, 2, v69
  v_lshlrev_b32 v70, 2, v70
  v_lshlrev_b32 v71, 2, v71
  ds_add_rtn_u32 v172, v68, v11
  ds_add_rtn_u32 v173, v69, v11
  ds_add_rtn_u32 v174, v70, v11
  ds_add_rtn_u32 v175, v71, v11
  v_and_b32 v218, 7, v226
  v_and_b32 v219, 7, v227
  v_and_b32 v220, 7, v228
  v_and_b32 v221, 7, v229
  v_lshl_or_b32 v120, v120, 3, v218
  v_lshl_or_b32 v121, v121, 3, v219
  v_lshl_or_b32 v122, v122, 3, v220
  v_lshl_or_b32 v123, v123, 3, v221
  v_lshrrev_b32 v226, 3, v226
  v_lshrrev_b32 v227, 3, v227
  v_lshrrev_b32 v228, 3, v228
  v_lshrrev_b32 v229, 3, v229
  v_lshl_or_b32 v120, v120, 1, v12
  v_lshl_or_b32 v121, v121, 1, v12
  v_lshl_or_b32 v122, v122, 1, v12
  v_lshl_or_b32 v123, v123, 1, v12
  v_lshl_or_b32 v120, v226, 23, v120
  v_lshl_or_b32 v121, v227, 23, v121
  v_lshl_or_b32 v122, v228, 23, v122
  v_lshl_or_b32 v123, v229, 23, v123
  s_waitcnt vmcnt(6)
  buffer_load_dwordx2 v[192:193], v233, s[12:15], s85 offen nt
  s_add_u32 s85, s85, 4096
  buffer_load_dwordx2 v[194:195], v233, s[12:15], s85 offen nt
  s_add_u32 s85, s85, 4096
  v_mul_hi_u32_u24 v218, s80, v72
  v_mul_hi_u32_u24 v219, s80, v73
  v_mul_hi_u32_u24 v220, s80, v74
  v_mul_hi_u32_u24 v221, s80, v75
  v_mul_hi_u32_u24 v222, s81, v124
  v_mul_hi_u32_u24 v223, s81, v125
  v_mul_hi_u32_u24 v224, s81, v126
  v_mul_hi_u32_u24 v225, s81, v127
  v_mad_i32_i24 v226, v218, s82, v72
  v_mad_i32_i24 v227, v219, s82, v73
  v_mad_i32_i24 v228, v220, s82, v74
  v_mad_i32_i24 v229, v221, s82, v75
  v_lshl_add_u32 v72, v222, 8, v218
  v_lshl_add_u32 v73, v223, 8, v219
  v_lshl_add_u32 v74, v224, 8, v220
  v_lshl_add_u32 v75, v225, 8, v221
  v_lshlrev_b32 v72, 2, v72
  v_lshlrev_b32 v73, 2, v73
  v_lshlrev_b32 v74, 2, v74
  v_lshlrev_b32 v75, 2, v75
  ds_add_rtn_u32 v176, v72, v11
  ds_add_rtn_u32 v177, v73, v11
  ds_add_rtn_u32 v178, v74, v11
  ds_add_rtn_u32 v179, v75, v11
  v_and_b32 v218, 7, v226
  v_and_b32 v219, 7, v227
  v_and_b32 v220, 7, v228
  v_and_b32 v221, 7, v229
  v_lshl_or_b32 v124, v124, 3, v218
  v_lshl_or_b32 v125, v125, 3, v219
  v_lshl_or_b32 v126, v126, 3, v220
  v_lshl_or_b32 v127, v127, 3, v221
  v_lshrrev_b32 v226, 3, v226
  v_lshrrev_b32 v227, 3, v227
  v_lshrrev_b32 v228, 3, v228
  v_lshrrev_b32 v229, 3, v229
  v_lshl_or_b32 v124, v124, 1, v12
  v_lshl_or_b32 v125, v125, 1, v12
  v_lshl_or_b32 v126, v126, 1, v12
  v_lshl_or_b32 v127, v127, 1, v12
  v_lshl_or_b32 v124, v226, 23, v124
  v_lshl_or_b32 v125, v227, 23, v125
  v_lshl_or_b32 v126, v228, 23, v126
  v_lshl_or_b32 v127, v229, 23, v127
  s_waitcnt vmcnt(6)
  v_mul_hi_u32_u24 v218, s80, v76
  v_mul_hi_u32_u24 v219, s80, v77
  v_mul_hi_u32_u24 v220, s80, v78
  v_mul_hi_u32_u24 v221, s80, v79
  v_mul_hi_u32_u24 v222, s81, v128
  v_mul_hi_u32_u24 v223, s81, v129
  v_mul_hi_u32_u24 v224, s81, v130
  v_mul_hi_u32_u24 v225, s81, v131
  v_mad_i32_i24 v226, v218, s82, v76
  v_mad_i32_i24 v227, v219, s82, v77
  v_mad_i32_i24 v228, v220, s82, v78
  v_mad_i32_i24 v229, v221, s82, v79
  v_lshl_add_u32 v76, v222, 8, v218
  v_lshl_add_u32 v77, v223, 8, v219
  v_lshl_add_u32 v78, v224, 8, v220
  v_lshl_add_u32 v79, v225, 8, v221
  v_lshlrev_b32 v76, 2, v76
  v_lshlrev_b32 v77, 2, v77
  v_lshlrev_b32 v78, 2, v78
  v_lshlrev_b32 v79, 2, v79
  ds_add_rtn_u32 v180, v76, v11
  ds_add_rtn_u32 v181, v77, v11
  ds_add_rtn_u32 v182, v78, v11
  ds_add_rtn_u32 v183, v79, v11
  v_and_b32 v218, 7, v226
  v_and_b32 v219, 7, v227
  v_and_b32 v220, 7, v228
  v_and_b32 v221, 7, v229
  v_lshl_or_b32 v128, v128, 3, v218
  v_lshl_or_b32 v129, v129, 3, v219
  v_lshl_or_b32 v130, v130, 3, v220
  v_lshl_or_b32 v131, v131, 3, v221
  v_lshrrev_b32 v226, 3, v226
  v_lshrrev_b32 v227, 3, v227
  v_lshrrev_b32 v228, 3, v228
  v_lshrrev_b32 v229, 3, v229
  v_lshl_or_b32 v128, v128, 1, v12
  v_lshl_or_b32 v129, v129, 1, v12
  v_lshl_or_b32 v130, v130, 1, v12
  v_lshl_or_b32 v131, v131, 1, v12
  v_lshl_or_b32 v128, v226, 23, v128
  v_lshl_or_b32 v129, v227, 23, v129
  v_lshl_or_b32 v130, v228, 23, v130
  v_lshl_or_b32 v131, v229, 23, v131
  s_waitcnt vmcnt(4)
  v_mul_hi_u32_u24 v218, s80, v80
  v_mul_hi_u32_u24 v219, s80, v81
  v_mul_hi_u32_u24 v220, s80, v82
  v_mul_hi_u32_u24 v221, s80, v83
  v_mul_hi_u32_u24 v222, s81, v132
  v_mul_hi_u32_u24 v223, s81, v133
  v_mul_hi_u32_u24 v224, s81, v134
  v_mul_hi_u32_u24 v225, s81, v135
  v_mad_i32_i24 v226, v218, s82, v80
  v_mad_i32_i24 v227, v219, s82, v81
  v_mad_i32_i24 v228, v220, s82, v82
  v_mad_i32_i24 v229, v221, s82, v83
  v_lshl_add_u32 v80, v222, 8, v218
  v_lshl_add_u32 v81, v223, 8, v219
  v_lshl_add_u32 v82, v224, 8, v220
  v_lshl_add_u32 v83, v225, 8, v221
  v_lshlrev_b32 v80, 2, v80
  v_lshlrev_b32 v81, 2, v81
  v_lshlrev_b32 v82, 2, v82
  v_lshlrev_b32 v83, 2, v83
  ds_add_rtn_u32 v184, v80, v11
  ds_add_rtn_u32 v185, v81, v11
  ds_add_rtn_u32 v186, v82, v11
  ds_add_rtn_u32 v187, v83, v11
  v_and_b32 v218, 7, v226
  v_and_b32 v219, 7, v227
  v_and_b32 v220, 7, v228
  v_and_b32 v221, 7, v229
  v_lshl_or_b32 v132, v132, 3, v218
  v_lshl_or_b32 v133, v133, 3, v219
  v_lshl_or_b32 v134, v134, 3, v220
  v_lshl_or_b32 v135, v135, 3, v221
  v_lshrrev_b32 v226, 3, v226
  v_lshrrev_b32 v227, 3, v227
  v_lshrrev_b32 v228, 3, v228
  v_lshrrev_b32 v229, 3, v229
  v_lshl_or_b32 v132, v132, 1, v12
  v_lshl_or_b32 v133, v133, 1, v12
  v_lshl_or_b32 v134, v134, 1, v12
  v_lshl_or_b32 v135, v135, 1, v12
  v_lshl_or_b32 v132, v226, 23, v132
  v_lshl_or_b32 v133, v227, 23, v133
  v_lshl_or_b32 v134, v228, 23, v134
  v_lshl_or_b32 v135, v229, 23, v135
  s_waitcnt vmcnt(2)
  v_mul_hi_u32_u24 v218, s80, v84
  v_mul_hi_u32_u24 v219, s80, v85
  v_mul_hi_u32_u24 v222, s81, v136
  v_mul_hi_u32_u24 v223, s81, v137
  v_mad_i32_i24 v226, v218, s82, v84
  v_mad_i32_i24 v227, v219, s82, v85
  v_lshl_add_u32 v84, v222, 8, v218
  v_lshl_add_u32 v85, v223, 8, v219
  v_lshlrev_b32 v84, 2, v84
  v_lshlrev_b32 v85, 2, v85
  ds_add_rtn_u32 v188, v84, v11
  ds_add_rtn_u32 v189, v85, v11
  v_and_b32 v218, 7, v226
  v_and_b32 v219, 7, v227
  v_lshl_or_b32 v136, v136, 3, v218
  v_lshl_or_b32 v137, v137, 3, v219
  v_lshrrev_b32 v226, 3, v226
  v_lshrrev_b32 v227, 3, v227
  v_lshl_or_b32 v136, v136, 1, v12
  v_lshl_or_b32 v137, v137, 1, v12
  v_lshl_or_b32 v136, v226, 23, v136
  v_lshl_or_b32 v137, v227, 23, v137
  v_and_b32 v226, 0x3f0, v250
  v_lshrrev_b32 v230, 1, v0
  v_and_b32 v231, 1, v0
  v_lshlrev_b32 v230, 2, v230
  v_lshl_add_u32 v231, v231, 12, v230
  s_waitcnt lgkmcnt(0)
  s_barrier
  s_cmp_ge_u32 s33, 6
  s_cbranch_scc1 L_bin_s2
  ds_read_b128 v[218:221], v250
  ds_read_b128 v[196:199], v226 offset:0
  ds_read_b128 v[200:203], v226 offset:1024
  ds_read_b128 v[204:207], v226 offset:2048
  ds_read_b128 v[208:211], v226 offset:3072
  ds_read_b128 v[212:215], v226 offset:4096
  s_cmp_gt_u32 s33, 0
  s_cselect_b32 s72, 1, 0
  s_cmp_gt_u32 s33, 1
  s_cselect_b32 s73, 1, 0
  s_cmp_gt_u32 s33, 2
  s_cselect_b32 s74, 1, 0
  s_cmp_gt_u32 s33, 3
  s_cselect_b32 s75, 1, 0
  s_cmp_gt_u32 s33, 4
  s_cselect_b32 s76, 1, 0
  s_waitcnt lgkmcnt(5)
  v_add_u32 v223, v218, v219
  v_add_u32 v224, v223, v220
  v_add_u32 v225, v224, v221
  s_waitcnt lgkmcnt(4)
  v_add3_u32 v196, v196, v197, v198
  v_add_u32 v196, v196, v199
  v_mul_u32_u24 v227, s72, v196
  s_waitcnt lgkmcnt(3)
  v_add3_u32 v200, v200, v201, v202
  v_add_u32 v200, v200, v203
  v_mad_u32_u24 v227, v200, s73, v227
  s_waitcnt lgkmcnt(2)
  v_add3_u32 v204, v204, v205, v206
  v_add_u32 v204, v204, v207
  v_mad_u32_u24 v227, v204, s74, v227
  s_waitcnt lgkmcnt(1)
  v_add3_u32 v208, v208, v209, v210
  v_add_u32 v208, v208, v211
  v_mad_u32_u24 v227, v208, s75, v227
  s_waitcnt lgkmcnt(0)
  v_add3_u32 v212, v212, v213, v214
  v_add_u32 v212, v212, v215
  v_mad_u32_u24 v227, v212, s76, v227
  v_lshl_or_b32 v222, v227, 16, v225
  s_nop 1
  v_add_u32_dpp v222, v222, v222 row_shr:1 row_mask:0xf bank_mask:0xf bound_ctrl:0
  s_nop 1
  v_add_u32_dpp v222, v222, v222 row_shr:2 row_mask:0xf bank_mask:0xf bound_ctrl:0
  s_nop 1
  v_add_u32_dpp v222, v222, v222 row_shr:4 row_mask:0xf bank_mask:0xf bound_ctrl:0
  s_nop 1
  v_add_u32_dpp v222, v222, v222 row_shr:8 row_mask:0xf bank_mask:0xf bound_ctrl:0
  s_nop 1
  v_add_u32_dpp v222, v222, v222 row_bcast:15 row_mask:0xa bank_mask:0xf
  s_nop 1
  v_add_u32_dpp v222, v222, v222 row_bcast:31 row_mask:0xc bank_mask:0xf
  s_nop 0
  v_readlane_b32 s100, v222, 63
  v_sub_u32 v222, v222, v225
  s_lshr_b32 s100, s100, 16
  v_add_u32 v222, s100, v222
  v_add_u32 v225, v222, v224
  v_add_u32 v224, v222, v223
  v_add_u32 v223, v222, v218
  v_lshl_or_b32 v218, v222, 16, v218
  v_lshl_or_b32 v219, v223, 16, v219
  v_lshl_or_b32 v220, v224, 16, v220
  v_lshl_or_b32 v221, v225, 16, v221
  ds_write_b128 v250, v[218:221]
  s_waitcnt lgkmcnt(0)
L_bin_s2:
  s_lshl_b32 s100, s2, 13
  s_barrier
  ds_read_b32 v226, v231 offset:0
  ds_read_b32 v227, v231 offset:1024
  ds_read_b32 v228, v231 offset:2048
  ds_read_b32 v229, v231 offset:3072
  ds_read_u16 v36, v36 offset:2
  ds_read_u16 v37, v37 offset:2
  ds_read_u16 v38, v38 offset:2
  ds_read_u16 v39, v39 offset:2
  ds_read_u16 v40, v40 offset:2
  ds_read_u16 v41, v41 offset:2
  ds_read_u16 v42, v42 offset:2
  ds_read_u16 v43, v43 offset:2
  ds_read_u16 v44, v44 offset:2
  ds_read_u16 v45, v45 offset:2
  s_waitcnt lgkmcnt(10)
  v_alignbit_b32 v226, v226, v226, 16
  v_alignbit_b32 v227, v227, v227, 16
  v_alignbit_b32 v228, v228, v228, 16
  v_alignbit_b32 v229, v229, v229, 16
  buffer_store_dwordx4 v[226:229], v250, s[20:23], s100 offen sc1
  ds_read_u16 v46, v46 offset:2
  ds_read_u16 v47, v47 offset:2
  ds_read_u16 v48, v48 offset:2
  ds_read_u16 v49, v49 offset:2
  ds_read_u16 v50, v50 offset:2
  buffer_load_dwordx2 v[196:197], v233, s[12:15], s85 offen nt
  s_add_u32 s85, s85, 4096
  buffer_load_dwordx2 v[198:199], v233, s[12:15], s85 offen nt
  s_add_u32 s85, s85, 4096
  s_mov_b32 s83, 57348
  s_mov_b32 s101, 0
  s_lshl_b32 s41, s33, 16
  v_and_b32 v245, 15, v0
  v_lshl_add_u32 v245, v245, 4, s41
  v_add_u32 v247, 6272, v250
  buffer_load_dwordx2 v[200:201], v233, s[12:15], s85 offen nt
  s_add_u32 s85, s85, 4096
  buffer_load_dwordx2 v[202:203], v233, s[12:15], s85 offen nt
  s_add_u32 s85, s85, 4096
  s_waitcnt lgkmcnt(10)
  ds_read_u16 v51, v51 offset:2
  ds_read_u16 v52, v52 offset:2
  ds_read_u16 v53, v53 offset:2
  ds_read_u16 v54, v54 offset:2
  ds_read_u16 v55, v55 offset:2
  v_add_u32 v36, v36, v140
  v_add_u32 v37, v37, v141
  v_add_u32 v38, v38, v142
  v_add_u32 v39, v39, v143
  v_add_u32 v40, v40, v144
  v_mad_u32_u24 v36, v36, v237, v244
  v_mad_u32_u24 v37, v37, v237, v244
  v_mad_u32_u24 v38, v38, v237, v244
  v_mad_u32_u24 v39, v39, v237, v244
  v_mad_u32_u24 v40, v40, v237, v244
  v_and_b32 v218, 2, v36
  v_and_b32 v219, 2, v37
  v_and_b32 v220, 2, v38
  v_and_b32 v221, 2, v39
  v_and_b32 v222, 2, v40
  v_and_b32 v140, -4, v36
  v_and_b32 v141, -4, v37
  v_and_b32 v142, -4, v38
  v_and_b32 v143, -4, v39
  v_and_b32 v144, -4, v40
  v_lshl_add_u32 v36, v218, 1, v36
  v_lshl_add_u32 v37, v219, 1, v37
  v_lshl_add_u32 v38, v220, 1, v38
  v_lshl_add_u32 v39, v221, 1, v39
  v_lshl_add_u32 v40, v222, 1, v40
  buffer_load_dwordx2 v[204:205], v233, s[12:15], s85 offen nt
  s_add_u32 s85, s85, 4096
  buffer_load_dwordx2 v[206:207], v233, s[12:15], s85 offen nt
  s_add_u32 s85, s85, 4096
  s_waitcnt lgkmcnt(10)
  ds_read_u16 v56, v56 offset:2
  ds_read_u16 v57, v57 offset:2
  ds_read_u16 v58, v58 offset:2
  ds_read_u16 v59, v59 offset:2
  ds_read_u16 v60, v60 offset:2
  v_add_u32 v41, v41, v145
  v_add_u32 v42, v42, v146
  v_add_u32 v43, v43, v147
  v_add_u32 v44, v44, v148
  v_add_u32 v45, v45, v149
  v_mad_u32_u24 v41, v41, v237, v244
  v_mad_u32_u24 v42, v42, v237, v244
  v_mad_u32_u24 v43, v43, v237, v244
  v_mad_u32_u24 v44, v44, v237, v244
  v_mad_u32_u24 v45, v45, v237, v244
  v_and_b32 v218, 2, v41
  v_and_b32 v219, 2, v42
  v_and_b32 v220, 2, v43
  v_and_b32 v221, 2, v44
  v_and_b32 v222, 2, v45
  v_and_b32 v145, -4, v41
  v_and_b32 v146, -4, v42
  v_and_b32 v147, -4, v43
  v_and_b32 v148, -4, v44
  v_and_b32 v149, -4, v45
  v_lshl_add_u32 v41, v218, 1, v41
  v_lshl_add_u32 v42, v219, 1, v42
  v_lshl_add_u32 v43, v220, 1, v43
  v_lshl_add_u32 v44, v221, 1, v44
  v_lshl_add_u32 v45, v222, 1, v45
  buffer_load_dwordx2 v[208:209], v233, s[12:15], s85 offen nt
  s_add_u32 s85, s85, 4096
  buffer_load_dwordx2 v[210:211], v233, s[12:15], s85 offen nt
  s_add_u32 s85, s85, 4096
  s_waitcnt lgkmcnt(10)
  ds_read_u16 v61, v61 offset:2
  ds_read_u16 v62, v62 offset:2
  ds_read_u16 v63, v63 offset:2
  ds_read_u16 v64, v64 offset:2
  ds_read_u16 v65, v65 offset:2
  v_add_u32 v46, v46, v150
  v_add_u32 v47, v47, v151
  v_add_u32 v48, v48, v152
  v_add_u32 v49, v49, v153
  v_add_u32 v50, v50, v154
  v_mad_u32_u24 v46, v46, v237, v244
  v_mad_u32_u24 v47, v47, v237, v244
  v_mad_u32_u24 v48, v48, v237, v244
  v_mad_u32_u24 v49, v49, v237, v244
  v_mad_u32_u24 v50, v50, v237, v244
  v_and_b32 v218, 2, v46
  v_and_b32 v219, 2, v47
  v_and_b32 v220, 2, v48
  v_and_b32 v221, 2, v49
  v_and_b32 v222, 2, v50
  v_and_b32 v150, -4, v46
  v_and_b32 v151, -4, v47
  v_and_b32 v152, -4, v48
  v_and_b32 v153, -4, v49
  v_and_b32 v154, -4, v50
  v_lshl_add_u32 v46, v218, 1, v46
  v_lshl_add_u32 v47, v219, 1, v47
  v_lshl_add_u32 v48, v220, 1, v48
  v_lshl_add_u32 v49, v221, 1, v49
  v_lshl_add_u32 v50, v222, 1, v50
  buffer_load_dwordx2 v[212:213], v233, s[12:15], s85 offen nt
  s_add_u32 s85, s85, 4096
  buffer_load_dwordx2 v[214:215], v233, s[12:15], s85 offen nt
  s_add_u32 s85, s85, 4096
  s_waitcnt lgkmcnt(10)
  ds_read_u16 v66, v66 offset:2
  ds_read_u16 v67, v67 offset:2
  ds_read_u16 v68, v68 offset:2
  ds_read_u16 v69, v69 offset:2
  ds_read_u16 v70, v70 offset:2
  v_add_u32 v51, v51, v155
  v_add_u32 v52, v52, v156
  v_add_u32 v53, v53, v157
  v_add_u32 v54, v54, v158
  v_add_u32 v55, v55, v159
  v_mad_u32_u24 v51, v51, v237, v244
  v_mad_u32_u24 v52, v52, v237, v244
  v_mad_u32_u24 v53, v53, v237, v244
  v_mad_u32_u24 v54, v54, v237, v244
  v_mad_u32_u24 v55, v55, v237, v244
  v_and_b32 v218, 2, v51
  v_and_b32 v219, 2, v52
  v_and_b32 v220, 2, v53
  v_and_b32 v221, 2, v54
  v_and_b32 v222, 2, v55
  v_and_b32 v155, -4, v51
  v_and_b32 v156, -4, v52
  v_and_b32 v157, -4, v53
  v_and_b32 v158, -4, v54
  v_and_b32 v159, -4, v55
  v_lshl_add_u32 v51, v218, 1, v51
  v_lshl_add_u32 v52, v219, 1, v52
  v_lshl_add_u32 v53, v220, 1, v53
  v_lshl_add_u32 v54, v221, 1, v54
  v_lshl_add_u32 v55, v222, 1, v55
  buffer_load_dword v216, v235, s[12:15], s85 offen nt
  s_waitcnt lgkmcnt(10)
  ds_read_u16 v71, v71 offset:2
  ds_read_u16 v72, v72 offset:2
  ds_read_u16 v73, v73 offset:2
  ds_read_u16 v74, v74 offset:2
  ds_read_u16 v75, v75 offset:2
  v_add_u32 v56, v56, v160
  v_add_u32 v57, v57, v161
  v_add_u32 v58, v58, v162
  v_add_u32 v59, v59, v163
  v_add_u32 v60, v60, v164
  v_mad_u32_u24 v56, v56, v237, v244
  v_mad_u32_u24 v57, v57, v237, v244
  v_mad_u32_u24 v58, v58, v237, v244
  v_mad_u32_u24 v59, v59, v237, v244
  v_mad_u32_u24 v60, v60, v237, v244
  v_and_b32 v218, 2, v56
  v_and_b32 v219, 2, v57
  v_and_b32 v220, 2, v58
  v_and_b32 v221, 2, v59
  v_and_b32 v222, 2, v60
  v_and_b32 v160, -4, v56
  v_and_b32 v161, -4, v57
  v_and_b32 v162, -4, v58
  v_and_b32 v163, -4, v59
  v_and_b32 v164, -4, v60
  v_lshl_add_u32 v56, v218, 1, v56
  v_lshl_add_u32 v57, v219, 1, v57
  v_lshl_add_u32 v58, v220, 1, v58
  v_lshl_add_u32 v59, v221, 1, v59
  v_lshl_add_u32 v60, v222, 1, v60
  s_waitcnt lgkmcnt(10)
  ds_read_u16 v76, v76 offset:2
  ds_read_u16 v77, v77 offset:2
  ds_read_u16 v78, v78 offset:2
  ds_read_u16 v79, v79 offset:2
  ds_read_u16 v80, v80 offset:2
  v_add_u32 v61, v61, v165
  v_add_u32 v62, v62, v166
  v_add_u32 v63, v63, v167
  v_add_u32 v64, v64, v168
  v_add_u32 v65, v65, v169
  v_mad_u32_u24 v61, v61, v237, v244
  v_mad_u32_u24 v62, v62, v237, v244
  v_mad_u32_u24 v63, v63, v237, v244
  v_mad_u32_u24 v64, v64, v237, v244
  v_mad_u32_u24 v65, v65, v237, v244
  v_and_b32 v218, 2, v61
  v_and_b32 v219, 2, v62
  v_and_b32 v220, 2, v63
  v_and_b32 v221, 2, v64
  v_and_b32 v222, 2, v65
  v_and_b32 v165, -4, v61
  v_and_b32 v166, -4, v62
  v_and_b32 v167, -4, v63
  v_and_b32 v168, -4, v64
  v_and_b32 v169, -4, v65
  v_lshl_add_u32 v61, v218, 1, v61
  v_lshl_add_u32 v62, v219, 1, v62
  v_lshl_add_u32 v63, v220, 1, v63
  v_lshl_add_u32 v64, v221, 1, v64
  v_lshl_add_u32 v65, v222, 1, v65
  s_waitcnt lgkmcnt(10)
  ds_read_u16 v81, v81 offset:2
  ds_read_u16 v82, v82 offset:2
  ds_read_u16 v83, v83 offset:2
  ds_read_u16 v84, v84 offset:2
  ds_read_u16 v85, v85 offset:2
  v_add_u32 v66, v66, v170
  v_add_u32 v67, v67, v171
  v_add_u32 v68, v68, v172
  v_add_u32 v69, v69, v173
  v_add_u32 v70, v70, v174
  v_mad_u32_u24 v66, v66, v237, v244
  v_mad_u32_u24 v67, v67, v237, v244
  v_mad_u32_u24 v68, v68, v237, v244
  v_mad_u32_u24 v69, v69, v237, v244
  v_mad_u32_u24 v70, v70, v237, v244
  v_and_b32 v218, 2, v66
  v_and_b32 v219, 2, v67
  v_and_b32 v220, 2, v68
  v_and_b32 v221, 2, v69
  v_and_b32 v222, 2, v70
  v_and_b32 v170, -4, v66
  v_and_b32 v171, -4, v67
  v_and_b32 v172, -4, v68
  v_and_b32 v173, -4, v69
  v_and_b32 v174, -4, v70
  v_lshl_add_u32 v66, v218, 1, v66
  v_lshl_add_u32 v67, v219, 1, v67
  v_lshl_add_u32 v68, v220, 1, v68
  v_lshl_add_u32 v69, v221, 1, v69
  v_lshl_add_u32 v70, v222, 1, v70
  s_waitcnt lgkmcnt(10)
  v_add_u32 v71, v71, v175
  v_add_u32 v72, v72, v176
  v_add_u32 v73, v73, v177
  v_add_u32 v74, v74, v178
  v_add_u32 v75, v75, v179
  v_mad_u32_u24 v71, v71, v237, v244
  v_mad_u32_u24 v72, v72, v237, v244
  v_mad_u32_u24 v73, v73, v237, v244
  v_mad_u32_u24 v74, v74, v237, v244
  v_mad_u32_u24 v75, v75, v237, v244
  v_and_b32 v218, 2, v71
  v_and_b32 v219, 2, v72
  v_and_b32 v220, 2, v73
  v_and_b32 v221, 2, v74
  v_and_b32 v222, 2, v75
  v_and_b32 v175, -4, v71
  v_and_b32 v176, -4, v72
  v_and_b32 v177, -4, v73
  v_and_b32 v178, -4, v74
  v_and_b32 v179, -4, v75
  v_lshl_add_u32 v71, v218, 1, v71
  v_lshl_add_u32 v72, v219, 1, v72
  v_lshl_add_u32 v73, v220, 1, v73
  v_lshl_add_u32 v74, v221, 1, v74
  v_lshl_add_u32 v75, v222, 1, v75
  s_waitcnt lgkmcnt(5)
  v_add_u32 v76, v76, v180
  v_add_u32 v77, v77, v181
  v_add_u32 v78, v78, v182
  v_add_u32 v79, v79, v183
  v_add_u32 v80, v80, v184
  v_mad_u32_u24 v76, v76, v237, v244
  v_mad_u32_u24 v77, v77, v237, v244
  v_mad_u32_u24 v78, v78, v237, v244
  v_mad_u32_u24 v79, v79, v237, v244
  v_mad_u32_u24 v80, v80, v237, v244
  v_and_b32 v218, 2, v76
  v_and_b32 v219, 2, v77
  v_and_b32 v220, 2, v78
  v_and_b32 v221, 2, v79
  v_and_b32 v222, 2, v80
  v_and_b32 v180, -4, v76
  v_and_b32 v181, -4, v77
  v_and_b32 v182, -4, v78
  v_and_b32 v183, -4, v79
  v_and_b32 v184, -4, v80
  v_lshl_add_u32 v76, v218, 1, v76
  v_lshl_add_u32 v77, v219, 1, v77
  v_lshl_add_u32 v78, v220, 1, v78
  v_lshl_add_u32 v79, v221, 1, v79
  v_lshl_add_u32 v80, v222, 1, v80
  s_waitcnt lgkmcnt(0)
  v_add_u32 v81, v81, v185
  v_add_u32 v82, v82, v186
  v_add_u32 v83, v83, v187
  v_add_u32 v84, v84, v188
  v_add_u32 v85, v85, v189
  v_mad_u32_u24 v81, v81, v237, v244
  v_mad_u32_u24 v82, v82, v237, v244
  v_mad_u32_u24 v83, v83, v237, v244
  v_mad_u32_u24 v84, v84, v237, v244
  v_mad_u32_u24 v85, v85, v237, v244
  v_and_b32 v218, 2, v81
  v_and_b32 v219, 2, v82
  v_and_b32 v220, 2, v83
  v_and_b32 v221, 2, v84
  v_and_b32 v222, 2, v85
  v_and_b32 v185, -4, v81
  v_and_b32 v186, -4, v82
  v_and_b32 v187, -4, v83
  v_and_b32 v188, -4, v84
  v_and_b32 v189, -4, v85
  v_lshl_add_u32 v81, v218, 1, v81
  v_lshl_add_u32 v82, v219, 1, v82
  v_lshl_add_u32 v83, v220, 1, v83
  v_lshl_add_u32 v84, v221, 1, v84
  v_lshl_add_u32 v85, v222, 1, v85
  s_waitcnt vmcnt(13)
  v_and_b32 v192, 0x7fff7fff, v192
  v_and_b32 v193, 0x7fff7fff, v193
  v_cmp_gt_u32 s[72:73], s83, v140
  v_cmp_gt_u32 s[74:75], s83, v141
  v_cmp_gt_u32 s[76:77], s83, v142
  v_cmp_gt_u32 s[78:79], s83, v143
  s_mov_b64 exec, s[72:73]
  ds_write_b32 v140, v88 offset:6272
  ds_write_b16 v36, v192 offset:6270
  s_mov_b64 exec, s[74:75]
  ds_write_b32 v141, v89 offset:6272
  ds_write_b16_d16_hi v37, v192 offset:6270
  s_mov_b64 exec, s[76:77]
  ds_write_b32 v142, v90 offset:6272
  ds_write_b16 v38, v193 offset:6270
  s_mov_b64 exec, s[78:79]
  ds_write_b32 v143, v91 offset:6272
  ds_write_b16_d16_hi v39, v193 offset:6270
  s_mov_b64 exec, -1
  s_waitcnt vmcnt(12)
  v_and_b32 v194, 0x7fff7fff, v194
  v_and_b32 v195, 0x7fff7fff, v195
  v_cmp_gt_u32 s[72:73], s83, v144
  v_cmp_gt_u32 s[74:75], s83, v145
  v_cmp_gt_u32 s[76:77], s83, v146
  v_cmp_gt_u32 s[78:79], s83, v147
  s_mov_b64 exec, s[72:73]
  ds_write_b32 v144, v92 offset:6272
  ds_write_b16 v40, v194 offset:6270
  s_mov_b64 exec, s[74:75]
  ds_write_b32 v145, v93 offset:6272
  ds_write_b16_d16_hi v41, v194 offset:6270
  s_mov_b64 exec, s[76:77]
  ds_write_b32 v146, v94 offset:6272
  ds_write_b16 v42, v195 offset:6270
  s_mov_b64 exec, s[78:79]
  ds_write_b32 v147, v95 offset:6272
  ds_write_b16_d16_hi v43, v195 offset:6270
  s_mov_b64 exec, -1
  s_waitcnt vmcnt(10)
  v_and_b32 v196, 0x7fff7fff, v196
  v_and_b32 v197, 0x7fff7fff, v197
  v_cmp_gt_u32 s[72:73], s83, v148
  v_cmp_gt_u32 s[74:75], s83, v149
  v_cmp_gt_u32 s[76:77], s83, v150
  v_cmp_gt_u32 s[78:79], s83, v151
  s_mov_b64 exec, s[72:73]
  ds_write_b32 v148, v96 offset:6272
  ds_write_b16 v44, v196 offset:6270
  s_mov_b64 exec, s[74:75]
  ds_write_b32 v149, v97 offset:6272
  ds_write_b16_d16_hi v45, v196 offset:6270
  s_mov_b64 exec, s[76:77]
  ds_write_b32 v150, v98 offset:6272
  ds_write_b16 v46, v197 offset:6270
  s_mov_b64 exec, s[78:79]
  ds_write_b32 v151, v99 offset:6272
  ds_write_b16_d16_hi v47, v197 offset:6270
  s_mov_b64 exec, -1
  s_waitcnt vmcnt(9)
  v_and_b32 v198, 0x7fff7fff, v198
  v_and_b32 v199, 0x7fff7fff, v199
  s_barrier
  buffer_load_dword v246, v245, s[24:27], 0 offen sc1
  buffer_store_dword v11, v240, s[92:95], 0 offen sc1
  v_cmp_gt_u32 s[72:73], s83, v152
  v_cmp_gt_u32 s[74:75], s83, v153
  v_cmp_gt_u32 s[76:77], s83, v154
  v_cmp_gt_u32 s[78:79], s83, v155
  s_mov_b64 exec, s[72:73]
  ds_write_b32 v152, v100 offset:6272
  ds_write_b16 v48, v198 offset:6270
  s_mov_b64 exec, s[74:75]
  ds_write_b32 v153, v101 offset:6272
  ds_write_b16_d16_hi v49, v198 offset:6270
  s_mov_b64 exec, s[76:77]
  ds_write_b32 v154, v102 offset:6272
  ds_write_b16 v50, v199 offset:6270
  s_mov_b64 exec, s[78:79]
  ds_write_b32 v155, v103 offset:6272
  ds_write_b16_d16_hi v51, v199 offset:6270
  s_mov_b64 exec, -1
  s_waitcnt vmcnt(10)
  v_and_b32 v200, 0x7fff7fff, v200
  v_and_b32 v201, 0x7fff7fff, v201
  v_cmp_gt_u32 s[72:73], s83, v156
  v_cmp_gt_u32 s[74:75], s83, v157
  v_cmp_gt_u32 s[76:77], s83, v158
  v_cmp_gt_u32 s[78:79], s83, v159
  s_mov_b64 exec, s[72:73]
  ds_write_b32 v156, v104 offset:6272
  ds_write_b16 v52, v200 offset:6270
  s_mov_b64 exec, s[74:75]
  ds_write_b32 v157, v105 offset:6272
  ds_write_b16_d16_hi v53, v200 offset:6270
  s_mov_b64 exec, s[76:77]
  ds_write_b32 v158, v106 offset:6272
  ds_write_b16 v54, v201 offset:6270
  s_mov_b64 exec, s[78:79]
  ds_write_b32 v159, v107 offset:6272
  ds_write_b16_d16_hi v55, v201 offset:6270
  s_mov_b64 exec, -1
  s_waitcnt vmcnt(9)
  v_and_b32 v202, 0x7fff7fff, v202
  v_and_b32 v203, 0x7fff7fff, v203
  v_cmp_gt_u32 s[72:73], s83, v160
  v_cmp_gt_u32 s[74:75], s83, v161
  v_cmp_gt_u32 s[76:77], s83, v162
  v_cmp_gt_u32 s[78:79], s83, v163
  s_mov_b64 exec, s[72:73]
  ds_write_b32 v160, v108 offset:6272
  ds_write_b16 v56, v202 offset:6270
  s_mov_b64 exec, s[74:75]
  ds_write_b32 v161, v109 offset:6272
  ds_write_b16_d16_hi v57, v202 offset:6270
  s_mov_b64 exec, s[76:77]
  ds_write_b32 v162, v110 offset:6272
  ds_write_b16 v58, v203 offset:6270
  s_mov_b64 exec, s[78:79]
  ds_write_b32 v163, v111 offset:6272
  ds_write_b16_d16_hi v59, v203 offset:6270
  s_mov_b64 exec, -1
  s_waitcnt vmcnt(8)
  v_and_b32 v204, 0x7fff7fff, v204
  v_and_b32 v205, 0x7fff7fff, v205
  v_cmp_gt_u32 s[72:73], s83, v164
  v_cmp_gt_u32 s[74:75], s83, v165
  v_cmp_gt_u32 s[76:77], s83, v166
  v_cmp_gt_u32 s[78:79], s83, v167
  s_mov_b64 exec, s[72:73]
  ds_write_b32 v164, v112 offset:6272
  ds_write_b16 v60, v204 offset:6270
  s_mov_b64 exec, s[74:75]
  ds_write_b32 v165, v113 offset:6272
  ds_write_b16_d16_hi v61, v204 offset:6270
  s_mov_b64 exec, s[76:77]
  ds_write_b32 v166, v114 offset:6272
  ds_write_b16 v62, v205 offset:6270
  s_mov_b64 exec, s[78:79]
  ds_write_b32 v167, v115 offset:6272
  ds_write_b16_d16_hi v63, v205 offset:6270
  s_mov_b64 exec, -1
  s_waitcnt vmcnt(7)
  v_and_b32 v206, 0x7fff7fff, v206
  v_and_b32 v207, 0x7fff7fff, v207
  v_cmp_gt_u32 s[72:73], s83, v168
  v_cmp_gt_u32 s[74:75], s83, v169
  v_cmp_gt_u32 s[76:77], s83, v170
  v_cmp_gt_u32 s[78:79], s83, v171
  s_mov_b64 exec, s[72:73]
  ds_write_b32 v168, v116 offset:6272
  ds_write_b16 v64, v206 offset:6270
  s_mov_b64 exec, s[74:75]
  ds_write_b32 v169, v117 offset:6272
  ds_write_b16_d16_hi v65, v206 offset:6270
  s_mov_b64 exec, s[76:77]
  ds_write_b32 v170, v118 offset:6272
  ds_write_b16 v66, v207 offset:6270
  s_mov_b64 exec, s[78:79]
  ds_write_b32 v171, v119 offset:6272
  ds_write_b16_d16_hi v67, v207 offset:6270
  s_mov_b64 exec, -1
  s_waitcnt vmcnt(6)
  v_and_b32 v208, 0x7fff7fff, v208
  v_and_b32 v209, 0x7fff7fff, v209
  v_cmp_gt_u32 s[72:73], s83, v172
  v_cmp_gt_u32 s[74:75], s83, v173
  v_cmp_gt_u32 s[76:77], s83, v174
  v_cmp_gt_u32 s[78:79], s83, v175
  s_mov_b64 exec, s[72:73]
  ds_write_b32 v172, v120 offset:6272
  ds_write_b16 v68, v208 offset:6270
  s_mov_b64 exec, s[74:75]
  ds_write_b32 v173, v121 offset:6272
  ds_write_b16_d16_hi v69, v208 offset:6270
  s_mov_b64 exec, s[76:77]
  ds_write_b32 v174, v122 offset:6272
  ds_write_b16 v70, v209 offset:6270
  s_mov_b64 exec, s[78:79]
  ds_write_b32 v175, v123 offset:6272
  ds_write_b16_d16_hi v71, v209 offset:6270
  s_mov_b64 exec, -1
  s_waitcnt vmcnt(5)
  v_and_b32 v210, 0x7fff7fff, v210
  v_and_b32 v211, 0x7fff7fff, v211
  v_cmp_gt_u32 s[72:73], s83, v176
  v_cmp_gt_u32 s[74:75], s83, v177
  v_cmp_gt_u32 s[76:77], s83, v178
  v_cmp_gt_u32 s[78:79], s83, v179
  s_mov_b64 exec, s[72:73]
  ds_write_b32 v176, v124 offset:6272
  ds_write_b16 v72, v210 offset:6270
  s_mov_b64 exec, s[74:75]
  ds_write_b32 v177, v125 offset:6272
  ds_write_b16_d16_hi v73, v210 offset:6270
  s_mov_b64 exec, s[76:77]
  ds_write_b32 v178, v126 offset:6272
  ds_write_b16 v74, v211 offset:6270
  s_mov_b64 exec, s[78:79]
  ds_write_b32 v179, v127 offset:6272
  ds_write_b16_d16_hi v75, v211 offset:6270
  s_mov_b64 exec, -1
  s_waitcnt vmcnt(4)
  v_and_b32 v212, 0x7fff7fff, v212
  v_and_b32 v213, 0x7fff7fff, v213
  v_cmp_gt_u32 s[72:73], s83, v180
  v_cmp_gt_u32 s[74:75], s83, v181
  v_cmp_gt_u32 s[76:77], s83, v182
  v_cmp_gt_u32 s[78:79], s83, v183
  s_mov_b64 exec, s[72:73]
  ds_write_b32 v180, v128 offset:6272
  ds_write_b16 v76, v212 offset:6270
  s_mov_b64 exec, s[74:75]
  ds_write_b32 v181, v129 offset:6272
  ds_write_b16_d16_hi v77, v212 offset:6270
  s_mov_b64 exec, s[76:77]
  ds_write_b32 v182, v130 offset:6272
  ds_write_b16 v78, v213 offset:6270
  s_mov_b64 exec, s[78:79]
  ds_write_b32 v183, v131 offset:6272
  ds_write_b16_d16_hi v79, v213 offset:6270
  s_mov_b64 exec, -1
  s_waitcnt vmcnt(3)
  v_and_b32 v214, 0x7fff7fff, v214
  v_and_b32 v215, 0x7fff7fff, v215
  v_cmp_gt_u32 s[72:73], s83, v184
  v_cmp_gt_u32 s[74:75], s83, v185
  v_cmp_gt_u32 s[76:77], s83, v186
  v_cmp_gt_u32 s[78:79], s83, v187
  s_mov_b64 exec, s[72:73]
  ds_write_b32 v184, v132 offset:6272
  ds_write_b16 v80, v214 offset:6270
  s_mov_b64 exec, s[74:75]
  ds_write_b32 v185, v133 offset:6272
  ds_write_b16_d16_hi v81, v214 offset:6270
  s_mov_b64 exec, s[76:77]
  ds_write_b32 v186, v134 offset:6272
  ds_write_b16 v82, v215 offset:6270
  s_mov_b64 exec, s[78:79]
  ds_write_b32 v187, v135 offset:6272
  ds_write_b16_d16_hi v83, v215 offset:6270
  s_mov_b64 exec, -1
  s_waitcnt vmcnt(2)
  v_and_b32 v216, 0x7fff7fff, v216
  v_cmp_gt_u32 s[72:73], s83, v188
  v_cmp_gt_u32 s[74:75], s83, v189
  s_mov_b64 exec, s[72:73]
  ds_write_b32 v188, v136 offset:6272
  ds_write_b16 v84, v216 offset:6270
  s_mov_b64 exec, s[74:75]
  ds_write_b32 v189, v137 offset:6272
  ds_write_b16_d16_hi v85, v216 offset:6270
  s_mov_b64 exec, -1
  ds_read_u16 v243, v18 offset:2050
  s_waitcnt lgkmcnt(0)
  s_barrier
  v_readfirstlane_b32 s85, v243
  ds_read_b128 v[218:221], v247 offset:0
  ds_read_b128 v[222:225], v247 offset:8192
  ds_read_b128 v[226:229], v247 offset:16384
  s_waitcnt lgkmcnt(2)
  buffer_store_dwordx4 v[218:221], v250, s[96:99], s101 offen sc1
  s_add_u32 s101, s101, 8192
  s_waitcnt lgkmcnt(1)
  buffer_store_dwordx4 v[222:225], v250, s[96:99], s101 offen sc1
  s_add_u32 s101, s101, 8192
  s_waitcnt lgkmcnt(0)
  buffer_store_dwordx4 v[226:229], v250, s[96:99], s101 offen sc1
  s_add_u32 s101, s101, 8192
  v_cmp_le_u32 s[72:73], s83, v140
  v_cmp_le_u32 s[74:75], s83, v141
  v_cmp_le_u32 s[76:77], s83, v142
  v_cmp_le_u32 s[78:79], s83, v143
  s_mov_b64 exec, s[72:73]
  ds_write_b32 v140, v88 offset:6272
  ds_write_b16 v36, v192 offset:6270
  s_mov_b64 exec, s[74:75]
  ds_write_b32 v141, v89 offset:6272
  ds_write_b16_d16_hi v37, v192 offset:6270
  s_mov_b64 exec, s[76:77]
  ds_write_b32 v142, v90 offset:6272
  ds_write_b16 v38, v193 offset:6270
  s_mov_b64 exec, s[78:79]
  ds_write_b32 v143, v91 offset:6272
  ds_write_b16_d16_hi v39, v193 offset:6270
  s_mov_b64 exec, -1
  v_cmp_le_u32 s[72:73], s83, v144
  v_cmp_le_u32 s[74:75], s83, v145
  v_cmp_le_u32 s[76:77], s83, v146
  v_cmp_le_u32 s[78:79], s83, v147
  s_mov_b64 exec, s[72:73]
  ds_write_b32 v144, v92 offset:6272
  ds_write_b16 v40, v194 offset:6270
  s_mov_b64 exec, s[74:75]
  ds_write_b32 v145, v93 offset:6272
  ds_write_b16_d16_hi v41, v194 offset:6270
  s_mov_b64 exec, s[76:77]
  ds_write_b32 v146, v94 offset:6272
  ds_write_b16 v42, v195 offset:6270
  s_mov_b64 exec, s[78:79]
  ds_write_b32 v147, v95 offset:6272
  ds_write_b16_d16_hi v43, v195 offset:6270
  s_mov_b64 exec, -1
  ds_read_b128 v[36:39], v247 offset:24576
  ds_read_b128 v[88:91], v247 offset:32768
  ds_read_b128 v[140:143], v247 offset:40960
  ds_read_b128 v[40:43], v247 offset:49152
  v_cmp_le_u32 s[72:73], s83, v148
  v_cmp_le_u32 s[74:75], s83, v149
  v_cmp_le_u32 s[76:77], s83, v150
  v_cmp_le_u32 s[78:79], s83, v151
  s_mov_b64 exec, s[72:73]
  ds_write_b32 v148, v96 offset:6272
  ds_write_b16 v44, v196 offset:6270
  s_mov_b64 exec, s[74:75]
  ds_write_b32 v149, v97 offset:6272
  ds_write_b16_d16_hi v45, v196 offset:6270
  s_mov_b64 exec, s[76:77]
  ds_write_b32 v150, v98 offset:6272
  ds_write_b16 v46, v197 offset:6270
  s_mov_b64 exec, s[78:79]
  ds_write_b32 v151, v99 offset:6272
  ds_write_b16_d16_hi v47, v197 offset:6270
  s_mov_b64 exec, -1
  s_waitcnt lgkmcnt(0)
  buffer_store_dwordx4 v[36:39], v250, s[96:99], s101 offen sc1
  s_add_u32 s101, s101, 8192
  v_cmp_le_u32 s[72:73], s83, v152
  v_cmp_le_u32 s[74:75], s83, v153
  v_cmp_le_u32 s[76:77], s83, v154
  v_cmp_le_u32 s[78:79], s83, v155
  s_mov_b64 exec, s[72:73]
  ds_write_b32 v152, v100 offset:6272
  ds_write_b16 v48, v198 offset:6270
  s_mov_b64 exec, s[74:75]
  ds_write_b32 v153, v101 offset:6272
  ds_write_b16_d16_hi v49, v198 offset:6270
  s_mov_b64 exec, s[76:77]
  ds_write_b32 v154, v102 offset:6272
  ds_write_b16 v50, v199 offset:6270
  s_mov_b64 exec, s[78:79]
  ds_write_b32 v155, v103 offset:6272
  ds_write_b16_d16_hi v51, v199 offset:6270
  s_mov_b64 exec, -1
  buffer_store_dwordx4 v[88:91], v250, s[96:99], s101 offen sc1
  s_add_u32 s101, s101, 8192
  v_cmp_le_u32 s[72:73], s83, v156
  v_cmp_le_u32 s[74:75], s83, v157
  v_cmp_le_u32 s[76:77], s83, v158
  v_cmp_le_u32 s[78:79], s83, v159
  s_mov_b64 exec, s[72:73]
  ds_write_b32 v156, v104 offset:6272
  ds_write_b16 v52, v200 offset:6270
  s_mov_b64 exec, s[74:75]
  ds_write_b32 v157, v105 offset:6272
  ds_write_b16_d16_hi v53, v200 offset:6270
  s_mov_b64 exec, s[76:77]
  ds_write_b32 v158, v106 offset:6272
  ds_write_b16 v54, v201 offset:6270
  s_mov_b64 exec, s[78:79]
  ds_write_b32 v159, v107 offset:6272
  ds_write_b16_d16_hi v55, v201 offset:6270
  s_mov_b64 exec, -1
  buffer_store_dwordx4 v[140:143], v250, s[96:99], s101 offen sc1
  s_add_u32 s101, s101, 8192
  v_cmp_le_u32 s[72:73], s83, v160
  v_cmp_le_u32 s[74:75], s83, v161
  v_cmp_le_u32 s[76:77], s83, v162
  v_cmp_le_u32 s[78:79], s83, v163
  s_mov_b64 exec, s[72:73]
  ds_write_b32 v160, v108 offset:6272
  ds_write_b16 v56, v202 offset:6270
  s_mov_b64 exec, s[74:75]
  ds_write_b32 v161, v109 offset:6272
  ds_write_b16_d16_hi v57, v202 offset:6270
  s_mov_b64 exec, s[76:77]
  ds_write_b32 v162, v110 offset:6272
  ds_write_b16 v58, v203 offset:6270
  s_mov_b64 exec, s[78:79]
  ds_write_b32 v163, v111 offset:6272
  ds_write_b16_d16_hi v59, v203 offset:6270
  s_mov_b64 exec, -1
  buffer_store_dwordx4 v[40:43], v250, s[96:99], s101 offen sc1
  s_add_u32 s101, s101, 8192
  v_cmp_le_u32 s[72:73], s83, v164
  v_cmp_le_u32 s[74:75], s83, v165
  v_cmp_le_u32 s[76:77], s83, v166
  v_cmp_le_u32 s[78:79], s83, v167
  s_mov_b64 exec, s[72:73]
  ds_write_b32 v164, v112 offset:6272
  ds_write_b16 v60, v204 offset:6270
  s_mov_b64 exec, s[74:75]
  ds_write_b32 v165, v113 offset:6272
  ds_write_b16_d16_hi v61, v204 offset:6270
  s_mov_b64 exec, s[76:77]
  ds_write_b32 v166, v114 offset:6272
  ds_write_b16 v62, v205 offset:6270
  s_mov_b64 exec, s[78:79]
  ds_write_b32 v167, v115 offset:6272
  ds_write_b16_d16_hi v63, v205 offset:6270
  s_mov_b64 exec, -1
  v_cmp_le_u32 s[72:73], s83, v168
  v_cmp_le_u32 s[74:75], s83, v169
  v_cmp_le_u32 s[76:77], s83, v170
  v_cmp_le_u32 s[78:79], s83, v171
  s_mov_b64 exec, s[72:73]
  ds_write_b32 v168, v116 offset:6272
  ds_write_b16 v64, v206 offset:6270
  s_mov_b64 exec, s[74:75]
  ds_write_b32 v169, v117 offset:6272
  ds_write_b16_d16_hi v65, v206 offset:6270
  s_mov_b64 exec, s[76:77]
  ds_write_b32 v170, v118 offset:6272
  ds_write_b16 v66, v207 offset:6270
  s_mov_b64 exec, s[78:79]
  ds_write_b32 v171, v119 offset:6272
  ds_write_b16_d16_hi v67, v207 offset:6270
  s_mov_b64 exec, -1
  v_cmp_le_u32 s[72:73], s83, v172
  v_cmp_le_u32 s[74:75], s83, v173
  v_cmp_le_u32 s[76:77], s83, v174
  v_cmp_le_u32 s[78:79], s83, v175
  s_mov_b64 exec, s[72:73]
  ds_write_b32 v172, v120 offset:6272
  ds_write_b16 v68, v208 offset:6270
  s_mov_b64 exec, s[74:75]
  ds_write_b32 v173, v121 offset:6272
  ds_write_b16_d16_hi v69, v208 offset:6270
  s_mov_b64 exec, s[76:77]
  ds_write_b32 v174, v122 offset:6272
  ds_write_b16 v70, v209 offset:6270
  s_mov_b64 exec, s[78:79]
  ds_write_b32 v175, v123 offset:6272
  ds_write_b16_d16_hi v71, v209 offset:6270
  s_mov_b64 exec, -1
  v_cmp_le_u32 s[72:73], s83, v176
  v_cmp_le_u32 s[74:75], s83, v177
  v_cmp_le_u32 s[76:77], s83, v178
  v_cmp_le_u32 s[78:79], s83, v179
  s_mov_b64 exec, s[72:73]
  ds_write_b32 v176, v124 offset:6272
  ds_write_b16 v72, v210 offset:6270
  s_mov_b64 exec, s[74:75]
  ds_write_b32 v177, v125 offset:6272
  ds_write_b16_d16_hi v73, v210 offset:6270
  s_mov_b64 exec, s[76:77]
  ds_write_b32 v178, v126 offset:6272
  ds_write_b16 v74, v211 offset:6270
  s_mov_b64 exec, s[78:79]
  ds_write_b32 v179, v127 offset:6272
  ds_write_b16_d16_hi v75, v211 offset:6270
  s_mov_b64 exec, -1
  v_and_b32 v230, 63, v0
  v_lshlrev_b32 v230, 4, v230
  s_and_b32 s40, s2, 3
  s_lshl_b32 s40, s40, 10
  s_mov_b32 s84, 0
  s_cmp_lg_u32 s33, 0
  s_cbranch_scc1 L_nofl
  s_waitcnt vmcnt(8)
  v_cmp_gt_u32 vcc, 16, v246
  s_cbranch_vccnz L_nofl
  s_mov_b32 s84, 1
  buffer_load_dwordx4 v[148:151], v230, s[92:95], s40 offen sc1
L_nofl:
  v_cmp_le_u32 s[72:73], s83, v180
  v_cmp_le_u32 s[74:75], s83, v181
  v_cmp_le_u32 s[76:77], s83, v182
  v_cmp_le_u32 s[78:79], s83, v183
  s_mov_b64 exec, s[72:73]
  ds_write_b32 v180, v128 offset:6272
  ds_write_b16 v76, v212 offset:6270
  s_mov_b64 exec, s[74:75]
  ds_write_b32 v181, v129 offset:6272
  ds_write_b16_d16_hi v77, v212 offset:6270
  s_mov_b64 exec, s[76:77]
  ds_write_b32 v182, v130 offset:6272
  ds_write_b16 v78, v213 offset:6270
  s_mov_b64 exec, s[78:79]
  ds_write_b32 v183, v131 offset:6272
  ds_write_b16_d16_hi v79, v213 offset:6270
  s_mov_b64 exec, -1
  v_cmp_le_u32 s[72:73], s83, v184
  v_cmp_le_u32 s[74:75], s83, v185
  v_cmp_le_u32 s[76:77], s83, v186
  v_cmp_le_u32 s[78:79], s83, v187
  s_mov_b64 exec, s[72:73]
  ds_write_b32 v184, v132 offset:6272
  ds_write_b16 v80, v214 offset:6270
  s_mov_b64 exec, s[74:75]
  ds_write_b32 v185, v133 offset:6272
  ds_write_b16_d16_hi v81, v214 offset:6270
  s_mov_b64 exec, s[76:77]
  ds_write_b32 v186, v134 offset:6272
  ds_write_b16 v82, v215 offset:6270
  s_mov_b64 exec, s[78:79]
  ds_write_b32 v187, v135 offset:6272
  ds_write_b16_d16_hi v83, v215 offset:6270
  s_mov_b64 exec, -1
  v_cmp_le_u32 s[72:73], s83, v188
  v_cmp_le_u32 s[74:75], s83, v189
  s_mov_b64 exec, s[72:73]
  ds_write_b32 v188, v136 offset:6272
  ds_write_b16 v84, v216 offset:6270
  s_mov_b64 exec, s[74:75]
  ds_write_b32 v189, v137 offset:6272
  ds_write_b16_d16_hi v85, v216 offset:6270
  s_mov_b64 exec, -1
  s_waitcnt vmcnt(0)
  s_cmp_lg_u32 s33, 0
  s_cbranch_scc1 L_polled_t
  s_cmp_eq_u32 s84, 0
  s_cbranch_scc1 L_wait_a
  v_min3_u32 v148, v148, v149, v150
  v_min_u32 v148, v148, v151
  v_cmp_gt_u32 vcc, 1, v148
  s_cbranch_vccz L_polled_t
  s_branch L_polled_a
L_nochunk1:
  s_waitcnt vmcnt(0)
  s_and_b32 s100, s2, 15
  s_lshl_b32 s100, s100, 4
  v_lshlrev_b32 v218, 8, v0
  buffer_atomic_add v11, v218, s[24:27], s100 offen
  s_lshl_b32 s41, s33, 12
  s_add_u32 s41, s41, 8192
  v_and_b32 v169, 63, v0
  v_lshl_add_u32 v164, v169, 3, s41
  v_lshl_add_u32 v169, v169, 2, s41
  ds_write_b64 v164, v[196:197]
  ds_write_b64 v164, v[198:199] offset:512
  ds_write_b64 v164, v[200:201] offset:1024
  ds_write_b32 v169, v204 offset:1536
  ds_write_b64 v164, v[202:203] offset:2048
  v_and_b32 v165, 15, v0
  v_bfe_u32 v169, v0, 4, 2
  v_lshl_add_u32 v165, v165, 1, s41
  v_lshl_add_u32 v166, v169, 7, v165
  v_lshl_add_u32 v167, v169, 6, v165
  v_bfe_u32 v168, v0, 5, 1
  v_lshl_add_u32 v168, v168, 8, v165
  ds_read_u16 v232, v166 offset:512
  ds_read_u16 v234, v166 offset:544
  ds_read_u16 v180, v166 offset:576
  ds_read_u16 v181, v166 offset:608
  ds_read_u16 v238, v166 offset:1024
  ds_read_u16 v182, v166 offset:1056
  ds_read_u16 v239, v166 offset:1088
  ds_read_u16 v183, v166 offset:1120
  ds_read_u16 v236, v167 offset:1536
  ds_read_u16 v184, v167 offset:1568
  ds_read_u16 v248, v168 offset:2048
  ds_read_u16 v172, v168 offset:2080
  ds_read_u16 v249, v168 offset:2112
  ds_read_u16 v173, v168 offset:2144
  ds_read_u16 v251, v168 offset:2176
  ds_read_u16 v174, v168 offset:2208
  ds_read_u16 v217, v168 offset:2240
  ds_read_u16 v175, v168 offset:2272
  ds_read_u16 v26, v165 offset:0
  ds_read_u16 v27, v165 offset:32
  ds_read_u16 v29, v165 offset:64
  ds_read_u16 v30, v165 offset:96
  ds_read_u16 v31, v165 offset:128
  ds_read_u16 v32, v165 offset:160
  ds_read_u16 v33, v165 offset:192
  ds_read_u16 v34, v165 offset:224
  ds_read_u16 v35, v165 offset:256
  ds_read_u16 v86, v165 offset:288
  ds_read_u16 v87, v165 offset:320
  ds_read_u16 v190, v165 offset:352
  ds_read_u16 v191, v165 offset:384
  v_mov_b32 v171, s56
  v_cmp_eq_u32 vcc, 1, v169
  v_mov_b32 v170, s57
  v_cmp_eq_u32 s[76:77], 2, v169
  v_cndmask_b32 v171, v171, v170, vcc
  v_mov_b32 v170, s58
  v_cmp_eq_u32 vcc, 3, v169
  v_cndmask_b32 v171, v171, v170, s[76:77]
  v_mov_b32 v170, s59
  v_cndmask_b32 v171, v171, v170, vcc
  v_lshlrev_b32 v170, 16, v171
  v_and_b32 v171, 0xffff0000, v171
  s_mov_b32 s56, 0xc1200000
  s_mov_b32 s57, 0xc1200000
  s_mov_b32 s58, 0x3fb8aa3b
  s_mov_b32 s59, 0x3fb8aa3b
  s_waitcnt lgkmcnt(0)
  v_lshl_or_b32 v232, v180, 16, v232
  v_lshl_or_b32 v234, v181, 16, v234
  v_lshl_or_b32 v238, v182, 16, v238
  v_lshl_or_b32 v239, v183, 16, v239
  v_lshl_or_b32 v236, v184, 16, v236
  v_lshl_or_b32 v248, v172, 16, v248
  v_lshl_or_b32 v249, v173, 16, v249
  v_lshl_or_b32 v251, v174, 16, v251
  v_lshl_or_b32 v217, v175, 16, v217
  v_lshlrev_b32 v172, 16, v26
  v_lshlrev_b32 v174, 16, v27
  v_lshlrev_b32 v176, 16, v29
  v_pk_add_f32 v[172:173], v[172:173], v[170:171] op_sel_hi:[0,1] neg_lo:[0,1] neg_hi:[0,1]
  v_pk_add_f32 v[174:175], v[174:175], v[170:171] op_sel_hi:[0,1] neg_lo:[0,1] neg_hi:[0,1]
  v_pk_add_f32 v[176:177], v[176:177], v[170:171] op_sel_hi:[0,1] neg_lo:[0,1] neg_hi:[0,1]
  v_cvt_pk_bf16_f32 v172, 0, v172
  v_cvt_pk_bf16_f32 v173, 0, v173
  v_cvt_pk_bf16_f32 v174, 0, v174
  v_cvt_pk_bf16_f32 v175, 0, v175
  v_cvt_pk_bf16_f32 v176, 0, v176
  v_cvt_pk_bf16_f32 v177, 0, v177
  v_pk_mul_f32 v[172:173], v[172:173], v[172:173]
  v_pk_mul_f32 v[174:175], v[174:175], v[174:175]
  v_pk_mul_f32 v[176:177], v[176:177], v[176:177]
  v_cvt_pk_bf16_f32 v172, 0, v172
  v_cvt_pk_bf16_f32 v173, 0, v173
  v_cvt_pk_bf16_f32 v174, 0, v174
  v_cvt_pk_bf16_f32 v175, 0, v175
  v_cvt_pk_bf16_f32 v176, 0, v176
  v_cvt_pk_bf16_f32 v177, 0, v177
  v_pk_mul_f32 v[172:173], v[172:173], s[56:57]
  v_pk_mul_f32 v[174:175], v[174:175], s[56:57]
  v_pk_mul_f32 v[176:177], v[176:177], s[56:57]
  v_cvt_pk_bf16_f32 v172, 0, v172
  v_cvt_pk_bf16_f32 v173, 0, v173
  v_cvt_pk_bf16_f32 v174, 0, v174
  v_cvt_pk_bf16_f32 v175, 0, v175
  v_cvt_pk_bf16_f32 v176, 0, v176
  v_cvt_pk_bf16_f32 v177, 0, v177
  v_pk_mul_f32 v[172:173], v[172:173], s[58:59]
  v_pk_mul_f32 v[174:175], v[174:175], s[58:59]
  v_pk_mul_f32 v[176:177], v[176:177], s[58:59]
  v_exp_f32 v172, v172
  v_exp_f32 v173, v173
  v_exp_f32 v174, v174
  v_exp_f32 v175, v175
  v_exp_f32 v176, v176
  v_exp_f32 v177, v177
  v_cvt_pk_bf16_f32 v26, v172, v173
  v_cvt_pk_bf16_f32 v27, v174, v175
  v_cvt_pk_bf16_f32 v29, v176, v177
  v_lshlrev_b32 v172, 16, v30
  v_lshlrev_b32 v174, 16, v31
  v_lshlrev_b32 v176, 16, v32
  v_lshlrev_b32 v178, 16, v33
  v_lshlrev_b32 v180, 16, v34
  v_pk_add_f32 v[172:173], v[172:173], v[170:171] op_sel_hi:[0,1] neg_lo:[0,1] neg_hi:[0,1]
  v_pk_add_f32 v[174:175], v[174:175], v[170:171] op_sel_hi:[0,1] neg_lo:[0,1] neg_hi:[0,1]
  v_pk_add_f32 v[176:177], v[176:177], v[170:171] op_sel_hi:[0,1] neg_lo:[0,1] neg_hi:[0,1]
  v_pk_add_f32 v[178:179], v[178:179], v[170:171] op_sel_hi:[0,1] neg_lo:[0,1] neg_hi:[0,1]
  v_pk_add_f32 v[180:181], v[180:181], v[170:171] op_sel_hi:[0,1] neg_lo:[0,1] neg_hi:[0,1]
  v_cvt_pk_bf16_f32 v172, 0, v172
  v_cvt_pk_bf16_f32 v173, 0, v173
  v_cvt_pk_bf16_f32 v174, 0, v174
  v_cvt_pk_bf16_f32 v175, 0, v175
  v_cvt_pk_bf16_f32 v176, 0, v176
  v_cvt_pk_bf16_f32 v177, 0, v177
  v_cvt_pk_bf16_f32 v178, 0, v178
  v_cvt_pk_bf16_f32 v179, 0, v179
  v_cvt_pk_bf16_f32 v180, 0, v180
  v_cvt_pk_bf16_f32 v181, 0, v181
  v_pk_mul_f32 v[172:173], v[172:173], v[172:173]
  v_pk_mul_f32 v[174:175], v[174:175], v[174:175]
  v_pk_mul_f32 v[176:177], v[176:177], v[176:177]
  v_pk_mul_f32 v[178:179], v[178:179], v[178:179]
  v_pk_mul_f32 v[180:181], v[180:181], v[180:181]
  v_cvt_pk_bf16_f32 v172, 0, v172
  v_cvt_pk_bf16_f32 v173, 0, v173
  v_cvt_pk_bf16_f32 v174, 0, v174
  v_cvt_pk_bf16_f32 v175, 0, v175
  v_cvt_pk_bf16_f32 v176, 0, v176
  v_cvt_pk_bf16_f32 v177, 0, v177
  v_cvt_pk_bf16_f32 v178, 0, v178
  v_cvt_pk_bf16_f32 v179, 0, v179
  v_cvt_pk_bf16_f32 v180, 0, v180
  v_cvt_pk_bf16_f32 v181, 0, v181
  v_pk_mul_f32 v[172:173], v[172:173], s[56:57]
  v_pk_mul_f32 v[174:175], v[174:175], s[56:57]
  v_pk_mul_f32 v[176:177], v[176:177], s[56:57]
  v_pk_mul_f32 v[178:179], v[178:179], s[56:57]
  v_pk_mul_f32 v[180:181], v[180:181], s[56:57]
  v_cvt_pk_bf16_f32 v172, 0, v172
  v_cvt_pk_bf16_f32 v173, 0, v173
  v_cvt_pk_bf16_f32 v174, 0, v174
  v_cvt_pk_bf16_f32 v175, 0, v175
  v_cvt_pk_bf16_f32 v176, 0, v176
  v_cvt_pk_bf16_f32 v177, 0, v177
  v_cvt_pk_bf16_f32 v178, 0, v178
  v_cvt_pk_bf16_f32 v179, 0, v179
  v_cvt_pk_bf16_f32 v180, 0, v180
  v_cvt_pk_bf16_f32 v181, 0, v181
  v_pk_mul_f32 v[172:173], v[172:173], s[58:59]
  v_pk_mul_f32 v[174:175], v[174:175], s[58:59]
  v_pk_mul_f32 v[176:177], v[176:177], s[58:59]
  v_pk_mul_f32 v[178:179], v[178:179], s[58:59]
  v_pk_mul_f32 v[180:181], v[180:181], s[58:59]
  v_exp_f32 v172, v172
  v_exp_f32 v173, v173
  v_exp_f32 v174, v174
  v_exp_f32 v175, v175
  v_exp_f32 v176, v176
  v_exp_f32 v177, v177
  v_exp_f32 v178, v178
  v_exp_f32 v179, v179
  v_exp_f32 v180, v180
  v_exp_f32 v181, v181
  v_cvt_pk_bf16_f32 v30, v172, v173
  v_cvt_pk_bf16_f32 v31, v174, v175
  v_cvt_pk_bf16_f32 v32, v176, v177
  v_cvt_pk_bf16_f32 v33, v178, v179
  v_cvt_pk_bf16_f32 v34, v180, v181
  v_lshlrev_b32 v172, 16, v35
  v_lshlrev_b32 v174, 16, v86
  v_lshlrev_b32 v176, 16, v87
  v_lshlrev_b32 v178, 16, v190
  v_lshlrev_b32 v180, 16, v191
  v_pk_add_f32 v[172:173], v[172:173], v[170:171] op_sel_hi:[0,1] neg_lo:[0,1] neg_hi:[0,1]
  v_pk_add_f32 v[174:175], v[174:175], v[170:171] op_sel_hi:[0,1] neg_lo:[0,1] neg_hi:[0,1]
  v_pk_add_f32 v[176:177], v[176:177], v[170:171] op_sel_hi:[0,1] neg_lo:[0,1] neg_hi:[0,1]
  v_pk_add_f32 v[178:179], v[178:179], v[170:171] op_sel_hi:[0,1] neg_lo:[0,1] neg_hi:[0,1]
  v_pk_add_f32 v[180:181], v[180:181], v[170:171] op_sel_hi:[0,1] neg_lo:[0,1] neg_hi:[0,1]
  v_cvt_pk_bf16_f32 v172, 0, v172
  v_cvt_pk_bf16_f32 v173, 0, v173
  v_cvt_pk_bf16_f32 v174, 0, v174
  v_cvt_pk_bf16_f32 v175, 0, v175
  v_cvt_pk_bf16_f32 v176, 0, v176
  v_cvt_pk_bf16_f32 v177, 0, v177
  v_cvt_pk_bf16_f32 v178, 0, v178
  v_cvt_pk_bf16_f32 v179, 0, v179
  v_cvt_pk_bf16_f32 v180, 0, v180
  v_cvt_pk_bf16_f32 v181, 0, v181
  v_pk_mul_f32 v[172:173], v[172:173], v[172:173]
  v_pk_mul_f32 v[174:175], v[174:175], v[174:175]
  v_pk_mul_f32 v[176:177], v[176:177], v[176:177]
  v_pk_mul_f32 v[178:179], v[178:179], v[178:179]
  v_pk_mul_f32 v[180:181], v[180:181], v[180:181]
  v_cvt_pk_bf16_f32 v172, 0, v172
  v_cvt_pk_bf16_f32 v173, 0, v173
  v_cvt_pk_bf16_f32 v174, 0, v174
  v_cvt_pk_bf16_f32 v175, 0, v175
  v_cvt_pk_bf16_f32 v176, 0, v176
  v_cvt_pk_bf16_f32 v177, 0, v177
  v_cvt_pk_bf16_f32 v178, 0, v178
  v_cvt_pk_bf16_f32 v179, 0, v179
  v_cvt_pk_bf16_f32 v180, 0, v180
  v_cvt_pk_bf16_f32 v181, 0, v181
  v_pk_mul_f32 v[172:173], v[172:173], s[56:57]
  v_pk_mul_f32 v[174:175], v[174:175], s[56:57]
  v_pk_mul_f32 v[176:177], v[176:177], s[56:57]
  v_pk_mul_f32 v[178:179], v[178:179], s[56:57]
  v_pk_mul_f32 v[180:181], v[180:181], s[56:57]
  v_cvt_pk_bf16_f32 v172, 0, v172
  v_cvt_pk_bf16_f32 v173, 0, v173
  v_cvt_pk_bf16_f32 v174, 0, v174
  v_cvt_pk_bf16_f32 v175, 0, v175
  v_cvt_pk_bf16_f32 v176, 0, v176
  v_cvt_pk_bf16_f32 v177, 0, v177
  v_cvt_pk_bf16_f32 v178, 0, v178
  v_cvt_pk_bf16_f32 v179, 0, v179
  v_cvt_pk_bf16_f32 v180, 0, v180
  v_cvt_pk_bf16_f32 v181, 0, v181
  v_pk_mul_f32 v[172:173], v[172:173], s[58:59]
  v_pk_mul_f32 v[174:175], v[174:175], s[58:59]
  v_pk_mul_f32 v[176:177], v[176:177], s[58:59]
  v_pk_mul_f32 v[178:179], v[178:179], s[58:59]
  v_pk_mul_f32 v[180:181], v[180:181], s[58:59]
  v_exp_f32 v172, v172
  v_exp_f32 v173, v173
  v_exp_f32 v174, v174
  v_exp_f32 v175, v175
  v_exp_f32 v176, v176
  v_exp_f32 v177, v177
  v_exp_f32 v178, v178
  v_exp_f32 v179, v179
  v_exp_f32 v180, v180
  v_exp_f32 v181, v181
  v_cvt_pk_bf16_f32 v35, v172, v173
  v_cvt_pk_bf16_f32 v86, v174, v175
  v_cvt_pk_bf16_f32 v87, v176, v177
  v_cvt_pk_bf16_f32 v190, v178, v179
  v_cvt_pk_bf16_f32 v191, v180, v181
  s_lshl_b32 s41, s33, 16
  v_and_b32 v245, 15, v0
  v_lshl_add_u32 v245, v245, 4, s41
  v_and_b32 v230, 63, v0
  v_lshlrev_b32 v230, 4, v230
  s_and_b32 s40, s2, 3
  s_lshl_b32 s40, s40, 10
  s_mov_b32 s85, 0
  s_cmp_lg_u32 s33, 0
  s_cbranch_scc1 L_polled_t
  s_mov_b32 s100, 60000
L_poll_a0:
  buffer_load_dword v246, v245, s[24:27], 0 offen sc1
  s_waitcnt vmcnt(0)
  v_cmp_gt_u32 vcc, 16, v246
  s_cbranch_vccz L_polled_a0
  s_sleep 64
  s_sub_u32 s100, s100, 1
  s_cbranch_scc0 L_poll_a0
L_polled_a0:
  s_mov_b32 s100, 60000
L_poll_t0:
  buffer_load_dwordx4 v[68:71], v230, s[92:95], s40 offen sc1
  s_waitcnt vmcnt(0)
  v_min3_u32 v68, v68, v69, v70
  v_min_u32 v68, v68, v71
  v_cmp_gt_u32 vcc, 1, v68
  s_cbranch_vccz L_polled_t0
  s_sleep 64
  s_sub_u32 s100, s100, 1
  s_cbranch_scc0 L_poll_t0
L_polled_t0:
  s_branch L_polled_t
L_wait_a:
  s_mov_b32 s100, 60000
L_poll_a:
  buffer_load_dword v246, v245, s[24:27], 0 offen sc1
  s_waitcnt vmcnt(0)
  v_cmp_gt_u32 vcc, 16, v246
  s_cbranch_vccz L_polled_a
  s_sleep 64
  s_sub_u32 s100, s100, 1
  s_cbranch_scc0 L_poll_a
L_polled_a:
  s_mov_b32 s100, 60000
L_poll_t:
  buffer_load_dwordx4 v[68:71], v230, s[92:95], s40 offen sc1
  s_waitcnt vmcnt(0)
  v_min3_u32 v68, v68, v69, v70
  v_min_u32 v68, v68, v71
  v_cmp_gt_u32 vcc, 1, v68
  s_cbranch_vccz L_polled_t
  s_sleep 8
  s_sub_u32 s100, s100, 1
  s_cbranch_scc0 L_poll_t
L_polled_t:
  s_lshl_b32 s41, s32, 5
  s_add_u32 s41, s41, 41943040
  s_add_u32 s16, s46, s41
  s_addc_u32 s17, s47, 0
  s_mov_b32 s18, 2039840
  s_mov_b32 s19, 0x20000
  v_add_u32 v220, 6272, v250
  v_add_u32 v221, 71808, v250
  v_add_u32 v222, 137344, v250
  s_mov_b32 s101, 57344
  v_mov_b32 v241, 3
  s_waitcnt lgkmcnt(0)
  s_barrier
  s_cmp_gt_u32 s85, 9555
  s_cbranch_scc1 L_noearly
  buffer_store_dword v241, v240, s[92:95], 0 offen sc1
L_noearly:
  buffer_load_dwordx4 v[20:23], v242, s[16:19], 0 offen sc1
  buffer_load_dwordx2 v[24:25], v242, s[16:19], 0 offen offset:16 sc1
  s_getpc_b64 s[24:25]
L_cp2:
  s_sub_u32 s24, s24, L_cp2-gather_scatter__molecular_angular_gemnet__graph_kernel
  s_subb_u32 s25, s25, 0
  s_mov_b32 s26, L_code_end-gather_scatter__molecular_angular_gemnet__graph_kernel
  s_mov_b32 s27, 0x20000
  buffer_load_dword v254, v255, s[24:27], 0 offen
  ds_read_b128 v[88:91], v220 offset:57344
  ds_read_b128 v[116:119], v221 offset:0
  ds_read_b128 v[120:123], v221 offset:8192
  ds_read_b128 v[124:127], v221 offset:16384
  ds_read_b128 v[128:131], v221 offset:24576
  ds_read_b128 v[132:135], v221 offset:32768
  ds_read_b128 v[136:139], v221 offset:40960
  ds_read_b128 v[140:143], v221 offset:49152
  ds_read_b128 v[144:147], v221 offset:57344
  ds_read_b128 v[148:151], v222 offset:0
  ds_read_b128 v[152:155], v222 offset:8192
  ds_read_b128 v[156:159], v222 offset:16384
  s_waitcnt lgkmcnt(11)
  buffer_store_dwordx4 v[88:91], v250, s[96:99], s101 offen sc1
  s_add_u32 s101, s101, 8192
  s_waitcnt lgkmcnt(10)
  buffer_store_dwordx4 v[116:119], v250, s[96:99], s101 offen sc1
  s_add_u32 s101, s101, 8192
  s_waitcnt lgkmcnt(0)
  s_cmp_gt_u32 s85, 9555
  s_cbranch_scc1 L_allfirst
  s_barrier
L_allfirst_back:
  buffer_store_dwordx4 v[120:123], v250, s[96:99], s101 offen sc1
  s_add_u32 s101, s101, 8192
  s_mul_i32 s41, s33, 3584
  s_add_u32 s41, s41, 114816
  v_and_b32 v226, 63, v0
  v_lshl_add_u32 v227, v226, 3, s41
  v_bfe_u32 v226, v0, 4, 1
  v_cmp_eq_u32 vcc, 1, v226
  ds_write_b32 v227, v26 offset:0
  ds_write_b32 v227, v27 offset:4
  ds_write_b32 v227, v29 offset:512
  ds_write_b32 v227, v30 offset:516
  ds_write_b32 v227, v31 offset:1024
  ds_write_b32 v227, v32 offset:1028
  ds_write_b32 v227, v33 offset:1536
  ds_write_b32 v227, v34 offset:1540
  ds_write_b32 v227, v35 offset:2048
  ds_write_b32 v227, v86 offset:2052
  ds_write_b32 v227, v87 offset:2560
  ds_write_b32 v227, v190 offset:2564
  ds_write_b32 v227, v191 offset:3072
  ds_write_b32 v227, v18 offset:3076
  v_cndmask_b32 v36, v248, v18, vcc
  v_cndmask_b32 v40, v18, v248, vcc
  v_cndmask_b32 v37, v249, v18, vcc
  v_cndmask_b32 v41, v18, v249, vcc
  v_cndmask_b32 v38, v251, v18, vcc
  v_cndmask_b32 v42, v18, v251, vcc
  v_cndmask_b32 v39, v217, v18, vcc
  v_cndmask_b32 v43, v18, v217, vcc
  v_mov_b32 v233, 0
  v_mov_b32 v235, 0
  v_mov_b32 v237, 0
  v_mov_b32 v26, 0
  v_mov_b32 v27, 0
  v_mov_b32 v30, 0
  v_mov_b64 v[44:45], 0
  v_mov_b64 v[46:47], 0
  v_mov_b64 v[48:49], 0
  v_mov_b64 v[50:51], 0
  v_mov_b64 v[52:53], 0
  v_mov_b64 v[54:55], 0
  v_mov_b64 v[56:57], 0
  v_mov_b64 v[58:59], 0
  v_mov_b64 v[60:61], 0
  v_mov_b64 v[62:63], 0
  buffer_store_dwordx4 v[124:127], v250, s[96:99], s101 offen sc1
  s_add_u32 s101, s101, 8192
  s_mul_i32 s42, s32, 147456
  s_add_u32 s42, s42, 50331648
  s_mov_b32 s8, s46
  s_mov_b32 s9, s47
  s_mov_b32 s10, 38400000
  s_mov_b32 s11, 0x20000
  s_mov_b32 s4, s48
  s_or_b32 s5, s49, 0x20000
  s_mov_b32 s6, 6400000
  s_mov_b32 s7, 0x20000
  s_add_u32 s12, s46, s42
  s_addc_u32 s13, s47, 0
  s_mov_b32 s14, 147456
  s_mov_b32 s15, 0x20000
  s_mov_b32 s20, s70
  s_mov_b32 s21, s71
  s_mov_b32 s22, s39
  s_mov_b32 s23, 0x20000
  s_mov_b32 s28, s48
  s_mov_b32 s29, s49
  s_mov_b32 s30, s39
  s_mov_b32 s31, 0x20000
  v_mov_b64 v[92:93], 0
  v_mov_b64 v[94:95], 0
  v_mov_b64 v[96:97], 0
  v_mov_b64 v[98:99], 0
  v_mov_b64 v[100:101], 0
  v_mov_b64 v[102:103], 0
  v_mov_b64 v[104:105], 0
  v_mov_b64 v[106:107], 0
  v_mov_b64 v[108:109], 0
  v_mov_b64 v[110:111], 0
  v_mov_b64 v[112:113], 0
  v_mov_b64 v[114:115], 0
  v_mov_b64 v[160:161], 0
  v_mov_b64 v[162:163], 0
  v_mov_b64 v[164:165], 0
  v_mov_b64 v[166:167], 0
  v_mov_b64 v[168:169], 0
  v_mov_b64 v[170:171], 0
  v_mov_b64 v[172:173], 0
  v_mov_b64 v[174:175], 0
  v_mov_b64 v[176:177], 0
  v_mov_b64 v[178:179], 0
  v_mov_b64 v[80:81], 0
  v_mov_b64 v[82:83], 0
  v_mov_b64 v[84:85], 0
  v_mov_b64 v[86:87], 0
  v_mov_b32 v35, 8388592
  v_mov_b32 v218, 0
  v_mov_b32 v219, v35
  v_mov_b32 v220, 0
  v_mov_b32 v221, v35
  v_add_u32 v224, 57344, v250
  ds_write_b128 v250, v[218:221] offset:0
  ds_write_b128 v250, v[218:221] offset:8192
  ds_write_b128 v250, v[218:221] offset:16384
  ds_write_b128 v250, v[218:221] offset:24576
  ds_write_b128 v250, v[218:221] offset:32768
  buffer_store_dwordx4 v[128:131], v250, s[96:99], s101 offen sc1
  s_add_u32 s101, s101, 8192
  ds_write_b128 v250, v[218:221] offset:40960
  ds_write_b128 v250, v[218:221] offset:49152
  ds_write_b128 v224, v[218:221] offset:0
  ds_write_b128 v224, v[218:221] offset:8192
  ds_write_b128 v224, v[218:221] offset:16384
  ds_write_b128 v224, v[218:221] offset:24576
  ds_write_b128 v224, v[218:221] offset:32768
  ds_write_b128 v224, v[218:221] offset:40960
  v_and_b32 v224, 15, v0
  v_lshl_add_u32 v224, v224, 2, v17
  ds_write_b32 v224, v18
  ds_write_b128 v5, v[92:95]
  v_mov_b32 v245, v4
  v_mov_b32 v240, 0
  v_mov_b32 v246, v4
  v_mov_b32 v241, 0
  v_mov_b32 v247, v4
  v_mov_b32 v242, 0
  v_mov_b32 v248, v4
  v_mov_b32 v243, 0
  v_mov_b32 v249, v4
  v_mov_b32 v244, 0
  s_waitcnt vmcnt(6)
  v_lshrrev_b32 v29, 16, v20
  v_lshrrev_b32 v222, 16, v21
  v_add_u32 v29, v29, v222
  v_lshrrev_b32 v222, 16, v22
  v_add_u32 v29, v29, v222
  v_lshrrev_b32 v222, 16, v23
  v_add_u32 v29, v29, v222
  v_lshrrev_b32 v222, 16, v24
  v_add_u32 v29, v29, v222
  v_lshrrev_b32 v222, 16, v25
  v_add_u32 v29, v29, v222
  v_sub_u32 v29, v29, v30
  v_lshrrev_b32 v218, 16, v20
  v_and_b32 v219, 0xffff, v20
  v_min_u32 v33, 32, v27
  v_cmp_ge_u32 vcc, 32, v27
  v_sub_u32 v220, 32, v33
  v_add_u32 v32, v28, v219
  v_min_u32 v220, v218, v220
  v_mul_u32_u24 v32, 6, v32
  v_add_u32 v30, v33, v220
  v_mad_i32_i24 v32, v33, -6, v32
  v_lshlrev_b32 v34, 2, v30
  v_add_u32 v31, v28, v26
  v_mul_u32_u24 v31, 6, v31
  v_add_u32_dpp v180, v32, v6 row_newbcast:0 row_mask:0xf bank_mask:0xf
  v_sub_u32_dpp v181, v34, v8 row_newbcast:0 row_mask:0xf bank_mask:0xf
  v_add_u32_dpp v182, v32, v6 row_newbcast:1 row_mask:0xf bank_mask:0xf
  v_sub_u32_dpp v183, v34, v8 row_newbcast:1 row_mask:0xf bank_mask:0xf
  v_bfi_b32 v180, v16, v180, v181
  v_bfi_b32 v182, v16, v182, v183
  v_add_u32_dpp v184, v32, v6 row_newbcast:2 row_mask:0xf bank_mask:0xf
  v_sub_u32_dpp v185, v34, v8 row_newbcast:2 row_mask:0xf bank_mask:0xf
  v_add_u32_dpp v186, v32, v6 row_newbcast:3 row_mask:0xf bank_mask:0xf
  v_sub_u32_dpp v187, v34, v8 row_newbcast:3 row_mask:0xf bank_mask:0xf
  v_bfi_b32 v184, v16, v184, v185
  v_bfi_b32 v186, v16, v186, v187
  buffer_store_dwordx4 v[132:135], v250, s[96:99], s101 offen sc1
  s_add_u32 s101, s101, 8192
  v_add_u32_dpp v188, v32, v6 row_newbcast:4 row_mask:0xf bank_mask:0xf
  v_sub_u32_dpp v189, v34, v8 row_newbcast:4 row_mask:0xf bank_mask:0xf
  v_add_u32_dpp v190, v32, v6 row_newbcast:5 row_mask:0xf bank_mask:0xf
  v_sub_u32_dpp v191, v34, v8 row_newbcast:5 row_mask:0xf bank_mask:0xf
  v_bfi_b32 v188, v16, v188, v189
  v_bfi_b32 v190, v16, v190, v191
  s_cmp_lg_u32 s33, 0
  s_cbranch_scc1 L_noeb
  buffer_load_dwordx4 v[68:71], v230, s[92:95], s40 offen sc1
L_noeb:
  v_add_u32_dpp v192, v32, v6 row_newbcast:6 row_mask:0xf bank_mask:0xf
  v_sub_u32_dpp v193, v34, v8 row_newbcast:6 row_mask:0xf bank_mask:0xf
  v_add_u32_dpp v194, v32, v6 row_newbcast:7 row_mask:0xf bank_mask:0xf
  v_sub_u32_dpp v195, v34, v8 row_newbcast:7 row_mask:0xf bank_mask:0xf
  v_bfi_b32 v192, v16, v192, v193
  v_bfi_b32 v194, v16, v194, v195
  v_add_u32_dpp v196, v32, v6 row_newbcast:8 row_mask:0xf bank_mask:0xf
  v_sub_u32_dpp v197, v34, v8 row_newbcast:8 row_mask:0xf bank_mask:0xf
  v_add_u32_dpp v198, v32, v6 row_newbcast:9 row_mask:0xf bank_mask:0xf
  v_sub_u32_dpp v199, v34, v8 row_newbcast:9 row_mask:0xf bank_mask:0xf
  v_bfi_b32 v196, v16, v196, v197
  v_bfi_b32 v198, v16, v198, v199
  v_add_u32_dpp v200, v32, v6 row_newbcast:10 row_mask:0xf bank_mask:0xf
  v_sub_u32_dpp v201, v34, v8 row_newbcast:10 row_mask:0xf bank_mask:0xf
  v_add_u32_dpp v202, v32, v6 row_newbcast:11 row_mask:0xf bank_mask:0xf
  v_sub_u32_dpp v203, v34, v8 row_newbcast:11 row_mask:0xf bank_mask:0xf
  v_bfi_b32 v200, v16, v200, v201
  v_bfi_b32 v202, v16, v202, v203
  buffer_store_dwordx4 v[136:139], v250, s[96:99], s101 offen sc1
  s_add_u32 s101, s101, 8192
  v_add_u32_dpp v204, v32, v6 row_newbcast:12 row_mask:0xf bank_mask:0xf
  v_sub_u32_dpp v205, v34, v8 row_newbcast:12 row_mask:0xf bank_mask:0xf
  v_add_u32_dpp v206, v32, v6 row_newbcast:13 row_mask:0xf bank_mask:0xf
  v_sub_u32_dpp v207, v34, v8 row_newbcast:13 row_mask:0xf bank_mask:0xf
  v_bfi_b32 v204, v16, v204, v205
  v_bfi_b32 v206, v16, v206, v207
  v_add_u32_dpp v208, v32, v6 row_newbcast:14 row_mask:0xf bank_mask:0xf
  v_sub_u32_dpp v209, v34, v8 row_newbcast:14 row_mask:0xf bank_mask:0xf
  v_add_u32_dpp v210, v32, v6 row_newbcast:15 row_mask:0xf bank_mask:0xf
  v_sub_u32_dpp v211, v34, v8 row_newbcast:15 row_mask:0xf bank_mask:0xf
  v_bfi_b32 v208, v16, v208, v209
  v_bfi_b32 v210, v16, v210, v211
  v_add_u32 v26, 32, v26
  v_subrev_u32 v27, 32, v27
  v_add_u32 v219, v219, v220
  v_sub_u32 v218, v218, v220
  v_cndmask_b32 v26, v26, v219, vcc
  v_cndmask_b32 v27, v27, v218, vcc
  v_cndmask_b32 v20, v20, v21, vcc
  v_cndmask_b32 v21, v21, v22, vcc
  v_cndmask_b32 v22, v22, v23, vcc
  v_cndmask_b32 v23, v23, v24, vcc
  v_cndmask_b32 v24, v24, v25, vcc
  v_cndmask_b32 v25, v25, v18, vcc
  v_sub_u32 v29, v29, v30
  v_lshrrev_b32 v218, 16, v20
  v_and_b32 v219, 0xffff, v20
  v_min_u32 v33, 32, v27
  v_cmp_ge_u32 vcc, 32, v27
  v_sub_u32 v220, 32, v33
  v_add_u32 v32, v28, v219
  v_min_u32 v220, v218, v220
  v_mul_u32_u24 v32, 6, v32
  v_add_u32 v30, v33, v220
  v_mad_i32_i24 v32, v33, -6, v32
  v_lshlrev_b32 v34, 2, v30
  v_add_u32 v31, v28, v26
  v_mul_u32_u24 v31, 6, v31
  v_add_u32 v26, 32, v26
  v_subrev_u32 v27, 32, v27
  v_add_u32 v219, v219, v220
  v_sub_u32 v218, v218, v220
  v_cndmask_b32 v26, v26, v219, vcc
  v_cndmask_b32 v27, v27, v218, vcc
  v_cndmask_b32 v20, v20, v21, vcc
  v_cndmask_b32 v21, v21, v22, vcc
  v_cndmask_b32 v22, v22, v23, vcc
  v_cndmask_b32 v23, v23, v24, vcc
  v_cndmask_b32 v24, v24, v25, vcc
  v_cndmask_b32 v25, v25, v18, vcc
  buffer_store_dwordx4 v[140:143], v250, s[96:99], s101 offen sc1
  s_add_u32 s101, s101, 8192
  s_nop 0
  v_mov_b64 v[88:89], 0
  v_mov_b64 v[90:91], 0
  v_mov_b64 v[116:117], 0
  v_mov_b64 v[118:119], 0
  v_mov_b64 v[120:121], 0
  v_mov_b64 v[122:123], 0
  v_mov_b64 v[124:125], 0
  v_mov_b64 v[126:127], 0
  v_mov_b64 v[128:129], 0
  v_mov_b64 v[130:131], 0
  v_mov_b64 v[132:133], 0
  v_mov_b64 v[134:135], 0
  v_mov_b64 v[136:137], 0
  v_mov_b64 v[138:139], 0
  v_mov_b64 v[140:141], 0
  v_mov_b64 v[142:143], 0
  s_mov_b32 s35, 52544
  s_cmp_lg_u32 s33, 0
  s_cbranch_scc1 L_polled_b
  s_waitcnt vmcnt(2)
  v_min3_u32 v68, v68, v69, v70
  v_min_u32 v68, v68, v71
  v_cmp_gt_u32 vcc, 2, v68
  s_cbranch_vccz L_polled_b
  s_mov_b32 s100, 60000
L_poll_b:
  buffer_load_dwordx4 v[68:71], v230, s[92:95], s40 offen sc1
  s_waitcnt vmcnt(0)
  v_min3_u32 v68, v68, v69, v70
  v_min_u32 v68, v68, v71
  v_cmp_gt_u32 vcc, 2, v68
  s_cbranch_vccz L_polled_b
  s_sleep 8
  s_sub_u32 s100, s100, 1
  s_cbranch_scc0 L_poll_b
L_polled_b:
  s_waitcnt lgkmcnt(0)
  s_barrier
  buffer_load_dwordx2 v[180:181], v180, s[8:11], 0 offen sc1
  buffer_load_dwordx2 v[182:183], v182, s[8:11], 0 offen sc1
  buffer_load_dwordx2 v[184:185], v184, s[8:11], 0 offen sc1
  buffer_load_dwordx2 v[186:187], v186, s[8:11], 0 offen sc1
  buffer_load_dwordx2 v[188:189], v188, s[8:11], 0 offen sc1
  buffer_load_dwordx2 v[190:191], v190, s[8:11], 0 offen sc1
  buffer_load_dwordx2 v[192:193], v192, s[8:11], 0 offen sc1
  buffer_load_dwordx2 v[194:195], v194, s[8:11], 0 offen sc1
  v_cmp_lt_u32 vcc, 0, v29
  s_cbranch_vccz L_noflag_pro
  ds_write_b32 v17, v11 offset:4
L_noflag_pro:
  s_waitcnt vmcnt(4)
  v_cmp_gt_i32 vcc, 0, v180
  v_min_i32 v64, v180, v181
  v_cmp_gt_i32 s[72:73], 0, v64
  v_cndmask_b32_sdwa v180, v180, v181, vcc dst_sel:WORD_1 dst_unused:UNUSED_PAD src0_sel:WORD_1 src1_sel:WORD_0
  v_mov_b32 v181, v64
  v_cmp_gt_i32 vcc, 0, v182
  v_min_i32 v65, v182, v183
  v_cmp_gt_i32 s[74:75], 0, v65
  v_cndmask_b32_sdwa v182, v182, v183, vcc dst_sel:WORD_1 dst_unused:UNUSED_PAD src0_sel:WORD_1 src1_sel:WORD_0
  v_mov_b32 v183, v65
  v_cmp_gt_i32 vcc, 0, v184
  v_min_i32 v66, v184, v185
  v_cmp_gt_i32 s[76:77], 0, v66
  v_cndmask_b32_sdwa v184, v184, v185, vcc dst_sel:WORD_1 dst_unused:UNUSED_PAD src0_sel:WORD_1 src1_sel:WORD_0
  v_mov_b32 v185, v66
  v_cmp_gt_i32 vcc, 0, v186
  v_min_i32 v67, v186, v187
  v_cmp_gt_i32 s[78:79], 0, v67
  v_cndmask_b32_sdwa v186, v186, v187, vcc dst_sel:WORD_1 dst_unused:UNUSED_PAD src0_sel:WORD_1 src1_sel:WORD_0
  v_mov_b32 v187, v67
  v_bfe_u32 v64, v64, 23, 8
  v_bfe_u32 v65, v65, 23, 8
  v_bfe_u32 v66, v66, 23, 8
  v_bfe_u32 v67, v67, 23, 8
  v_mul_u32_u24 v64, v64, v15
  v_mul_u32_u24 v65, v65, v15
  v_mul_u32_u24 v66, v66, v15
  v_mul_u32_u24 v67, v67, v15
  s_mov_b64 exec, s[72:73]
  ds_add_rtn_u32 v44, v64, v11
  s_mov_b64 exec, s[74:75]
  ds_add_rtn_u32 v45, v65, v11
  s_mov_b64 exec, s[76:77]
  ds_add_rtn_u32 v46, v66, v11
  s_mov_b64 exec, s[78:79]
  ds_add_rtn_u32 v47, v67, v11
  s_mov_b64 exec, -1
  buffer_load_dwordx2 v[196:197], v196, s[8:11], 0 offen sc1
  buffer_load_dwordx2 v[198:199], v198, s[8:11], 0 offen sc1
  buffer_load_dwordx2 v[200:201], v200, s[8:11], 0 offen sc1
  buffer_load_dwordx2 v[202:203], v202, s[8:11], 0 offen sc1
  buffer_load_dwordx2 v[204:205], v204, s[8:11], 0 offen sc1
  buffer_load_dwordx2 v[206:207], v206, s[8:11], 0 offen sc1
  buffer_load_dwordx2 v[208:209], v208, s[8:11], 0 offen sc1
  buffer_load_dwordx2 v[210:211], v210, s[8:11], 0 offen sc1
  s_waitcnt vmcnt(8)
  v_cmp_gt_i32 vcc, 0, v188
  v_min_i32 v68, v188, v189
  v_cmp_gt_i32 s[80:81], 0, v68
  v_cndmask_b32_sdwa v188, v188, v189, vcc dst_sel:WORD_1 dst_unused:UNUSED_PAD src0_sel:WORD_1 src1_sel:WORD_0
  v_mov_b32 v189, v68
  v_cmp_gt_i32 vcc, 0, v190
  v_min_i32 v69, v190, v191
  v_cmp_gt_i32 s[82:83], 0, v69
  v_cndmask_b32_sdwa v190, v190, v191, vcc dst_sel:WORD_1 dst_unused:UNUSED_PAD src0_sel:WORD_1 src1_sel:WORD_0
  v_mov_b32 v191, v69
  v_cmp_gt_i32 vcc, 0, v192
  v_min_i32 v70, v192, v193
  v_cmp_gt_i32 s[84:85], 0, v70
  v_cndmask_b32_sdwa v192, v192, v193, vcc dst_sel:WORD_1 dst_unused:UNUSED_PAD src0_sel:WORD_1 src1_sel:WORD_0
  v_mov_b32 v193, v70
  v_cmp_gt_i32 vcc, 0, v194
  v_min_i32 v71, v194, v195
  v_cmp_gt_i32 s[86:87], 0, v71
  v_cndmask_b32_sdwa v194, v194, v195, vcc dst_sel:WORD_1 dst_unused:UNUSED_PAD src0_sel:WORD_1 src1_sel:WORD_0
  v_mov_b32 v195, v71
  v_bfe_u32 v68, v68, 23, 8
  v_bfe_u32 v69, v69, 23, 8
  v_bfe_u32 v70, v70, 23, 8
  v_bfe_u32 v71, v71, 23, 8
  v_mul_u32_u24 v68, v68, v15
  v_mul_u32_u24 v69, v69, v15
  v_mul_u32_u24 v70, v70, v15
  v_mul_u32_u24 v71, v71, v15
  s_mov_b64 exec, s[80:81]
  ds_add_rtn_u32 v48, v68, v11
  s_mov_b64 exec, s[82:83]
  ds_add_rtn_u32 v49, v69, v11
  s_mov_b64 exec, s[84:85]
  ds_add_rtn_u32 v50, v70, v11
  s_mov_b64 exec, s[86:87]
  ds_add_rtn_u32 v51, v71, v11
  s_mov_b64 exec, -1
  buffer_store_dwordx4 v[144:147], v250, s[96:99], s101 offen sc1
  s_add_u32 s101, s101, 8192
  s_waitcnt lgkmcnt(0)
  v_max3_u32 v218, v44, v45, v46
  v_max_u32 v218, v218, v47
  v_cmp_lt_u32 vcc, 31, v218
  s_cbranch_vccz L_pfast_0
  v_cmp_lt_u32 vcc, 63, v218
  s_cbranch_vccnz L_pslow_0
L_pback_0:
  v_subrev_u32 v222, 31, v44
  v_subrev_u32 v223, 31, v45
  v_subrev_u32 v224, 31, v46
  v_subrev_u32 v225, 31, v47
  s_mov_b64 exec, s[72:73]
  ds_max_i32 v64, v222 offset:52800
  s_mov_b64 exec, s[74:75]
  ds_max_i32 v65, v223 offset:52800
  s_mov_b64 exec, s[76:77]
  ds_max_i32 v66, v224 offset:52800
  s_mov_b64 exec, s[78:79]
  ds_max_i32 v67, v225 offset:52800
  s_mov_b64 exec, -1
  ds_write_b32 v17, v11 offset:4
  v_lshrrev_b32 v222, 5, v44
  v_lshrrev_b32 v223, 5, v45
  v_lshrrev_b32 v224, 5, v46
  v_lshrrev_b32 v225, 5, v47
  v_mad_u32_u24 v64, v222, s35, v64
  v_mad_u32_u24 v65, v223, s35, v65
  v_mad_u32_u24 v66, v224, s35, v66
  v_mad_u32_u24 v67, v225, s35, v67
L_pfast_0:
  v_lshl_add_u32 v64, v44, 3, v64
  v_lshl_add_u32 v65, v45, 3, v65
  v_lshl_add_u32 v66, v46, 3, v66
  v_lshl_add_u32 v67, v47, 3, v67
  s_mov_b64 exec, s[72:73]
  ds_write_b64 v64, v[180:181] offset:8
  s_mov_b64 exec, s[74:75]
  ds_write_b64 v65, v[182:183] offset:8
  s_mov_b64 exec, s[76:77]
  ds_write_b64 v66, v[184:185] offset:8
  s_mov_b64 exec, s[78:79]
  ds_write_b64 v67, v[186:187] offset:8
  s_mov_b64 exec, -1
  buffer_store_dwordx4 v[148:151], v250, s[96:99], s101 offen sc1
  s_add_u32 s101, s101, 8192
  s_waitcnt vmcnt(6)
  v_cmp_gt_i32 vcc, 0, v196
  v_min_i32 v72, v196, v197
  v_cmp_gt_i32 s[72:73], 0, v72
  v_cndmask_b32_sdwa v196, v196, v197, vcc dst_sel:WORD_1 dst_unused:UNUSED_PAD src0_sel:WORD_1 src1_sel:WORD_0
  v_mov_b32 v197, v72
  v_cmp_gt_i32 vcc, 0, v198
  v_min_i32 v73, v198, v199
  v_cmp_gt_i32 s[74:75], 0, v73
  v_cndmask_b32_sdwa v198, v198, v199, vcc dst_sel:WORD_1 dst_unused:UNUSED_PAD src0_sel:WORD_1 src1_sel:WORD_0
  v_mov_b32 v199, v73
  v_cmp_gt_i32 vcc, 0, v200
  v_min_i32 v74, v200, v201
  v_cmp_gt_i32 s[76:77], 0, v74
  v_cndmask_b32_sdwa v200, v200, v201, vcc dst_sel:WORD_1 dst_unused:UNUSED_PAD src0_sel:WORD_1 src1_sel:WORD_0
  v_mov_b32 v201, v74
  v_cmp_gt_i32 vcc, 0, v202
  v_min_i32 v75, v202, v203
  v_cmp_gt_i32 s[78:79], 0, v75
  v_cndmask_b32_sdwa v202, v202, v203, vcc dst_sel:WORD_1 dst_unused:UNUSED_PAD src0_sel:WORD_1 src1_sel:WORD_0
  v_mov_b32 v203, v75
  v_bfe_u32 v72, v72, 23, 8
  v_bfe_u32 v73, v73, 23, 8
  v_bfe_u32 v74, v74, 23, 8
  v_bfe_u32 v75, v75, 23, 8
  v_mul_u32_u24 v72, v72, v15
  v_mul_u32_u24 v73, v73, v15
  v_mul_u32_u24 v74, v74, v15
  v_mul_u32_u24 v75, v75, v15
  s_mov_b64 exec, s[72:73]
  ds_add_rtn_u32 v52, v72, v11
  s_mov_b64 exec, s[74:75]
  ds_add_rtn_u32 v53, v73, v11
  s_mov_b64 exec, s[76:77]
  ds_add_rtn_u32 v54, v74, v11
  s_mov_b64 exec, s[78:79]
  ds_add_rtn_u32 v55, v75, v11
  s_mov_b64 exec, -1
  v_max3_u32 v218, v48, v49, v50
  v_max_u32 v218, v218, v51
  v_cmp_lt_u32 vcc, 31, v218
  s_cbranch_vccz L_pfast_1
  v_cmp_lt_u32 vcc, 63, v218
  s_cbranch_vccnz L_pslow_1
L_pback_1:
  v_subrev_u32 v222, 31, v48
  v_subrev_u32 v223, 31, v49
  v_subrev_u32 v224, 31, v50
  v_subrev_u32 v225, 31, v51
  s_mov_b64 exec, s[80:81]
  ds_max_i32 v68, v222 offset:52800
  s_mov_b64 exec, s[82:83]
  ds_max_i32 v69, v223 offset:52800
  s_mov_b64 exec, s[84:85]
  ds_max_i32 v70, v224 offset:52800
  s_mov_b64 exec, s[86:87]
  ds_max_i32 v71, v225 offset:52800
  s_mov_b64 exec, -1
  ds_write_b32 v17, v11 offset:4
  v_lshrrev_b32 v222, 5, v48
  v_lshrrev_b32 v223, 5, v49
  v_lshrrev_b32 v224, 5, v50
  v_lshrrev_b32 v225, 5, v51
  v_mad_u32_u24 v68, v222, s35, v68
  v_mad_u32_u24 v69, v223, s35, v69
  v_mad_u32_u24 v70, v224, s35, v70
  v_mad_u32_u24 v71, v225, s35, v71
L_pfast_1:
  v_lshl_add_u32 v68, v48, 3, v68
  v_lshl_add_u32 v69, v49, 3, v69
  v_lshl_add_u32 v70, v50, 3, v70
  v_lshl_add_u32 v71, v51, 3, v71
  s_mov_b64 exec, s[80:81]
  ds_write_b64 v68, v[188:189] offset:8
  s_mov_b64 exec, s[82:83]
  ds_write_b64 v69, v[190:191] offset:8
  s_mov_b64 exec, s[84:85]
  ds_write_b64 v70, v[192:193] offset:8
  s_mov_b64 exec, s[86:87]
  ds_write_b64 v71, v[194:195] offset:8
  s_mov_b64 exec, -1
  buffer_store_dwordx4 v[152:155], v250, s[96:99], s101 offen sc1
  s_add_u32 s101, s101, 8192
  s_waitcnt vmcnt(3)
  v_cmp_gt_i32 vcc, 0, v204
  v_min_i32 v76, v204, v205
  v_cmp_gt_i32 s[80:81], 0, v76
  v_cndmask_b32_sdwa v204, v204, v205, vcc dst_sel:WORD_1 dst_unused:UNUSED_PAD src0_sel:WORD_1 src1_sel:WORD_0
  v_mov_b32 v205, v76
  v_cmp_gt_i32 vcc, 0, v206
  v_min_i32 v77, v206, v207
  v_cmp_gt_i32 s[82:83], 0, v77
  v_cndmask_b32_sdwa v206, v206, v207, vcc dst_sel:WORD_1 dst_unused:UNUSED_PAD src0_sel:WORD_1 src1_sel:WORD_0
  v_mov_b32 v207, v77
  v_cmp_gt_i32 vcc, 0, v208
  v_min_i32 v78, v208, v209
  v_cmp_gt_i32 s[84:85], 0, v78
  v_cndmask_b32_sdwa v208, v208, v209, vcc dst_sel:WORD_1 dst_unused:UNUSED_PAD src0_sel:WORD_1 src1_sel:WORD_0
  v_mov_b32 v209, v78
  v_cmp_gt_i32 vcc, 0, v210
  v_min_i32 v79, v210, v211
  v_cmp_gt_i32 s[86:87], 0, v79
  v_cndmask_b32_sdwa v210, v210, v211, vcc dst_sel:WORD_1 dst_unused:UNUSED_PAD src0_sel:WORD_1 src1_sel:WORD_0
  v_mov_b32 v211, v79
  v_bfe_u32 v76, v76, 23, 8
  v_bfe_u32 v77, v77, 23, 8
  v_bfe_u32 v78, v78, 23, 8
  v_bfe_u32 v79, v79, 23, 8
  v_mul_u32_u24 v76, v76, v15
  v_mul_u32_u24 v77, v77, v15
  v_mul_u32_u24 v78, v78, v15
  v_mul_u32_u24 v79, v79, v15
  s_mov_b64 exec, s[80:81]
  ds_add_rtn_u32 v56, v76, v11
  s_mov_b64 exec, s[82:83]
  ds_add_rtn_u32 v57, v77, v11
  s_mov_b64 exec, s[84:85]
  ds_add_rtn_u32 v58, v78, v11
  s_mov_b64 exec, s[86:87]
  ds_add_rtn_u32 v59, v79, v11
  s_mov_b64 exec, -1
  buffer_store_dwordx4 v[156:159], v250, s[96:99], s101 offen sc1
  s_add_u32 s101, s101, 8192
  s_nop 0
  v_mov_b64 v[144:145], 0
  v_mov_b64 v[146:147], 0
  v_mov_b64 v[148:149], 0
  v_mov_b64 v[150:151], 0
  v_mov_b64 v[152:153], 0
  v_mov_b64 v[154:155], 0
  v_mov_b64 v[156:157], 0
  v_mov_b64 v[158:159], 0
  s_waitcnt lgkmcnt(0)
  v_max3_u32 v218, v52, v53, v54
  v_max_u32 v218, v218, v55
  v_cmp_lt_u32 vcc, 31, v218
  s_cbranch_vccz L_pfast_2
  v_cmp_lt_u32 vcc, 63, v218
  s_cbranch_vccnz L_pslow_2
L_pback_2:
  v_subrev_u32 v222, 31, v52
  v_subrev_u32 v223, 31, v53
  v_subrev_u32 v224, 31, v54
  v_subrev_u32 v225, 31, v55
  s_mov_b64 exec, s[72:73]
  ds_max_i32 v72, v222 offset:52800
  s_mov_b64 exec, s[74:75]
  ds_max_i32 v73, v223 offset:52800
  s_mov_b64 exec, s[76:77]
  ds_max_i32 v74, v224 offset:52800
  s_mov_b64 exec, s[78:79]
  ds_max_i32 v75, v225 offset:52800
  s_mov_b64 exec, -1
  ds_write_b32 v17, v11 offset:4
  v_lshrrev_b32 v222, 5, v52
  v_lshrrev_b32 v223, 5, v53
  v_lshrrev_b32 v224, 5, v54
  v_lshrrev_b32 v225, 5, v55
  v_mad_u32_u24 v72, v222, s35, v72
  v_mad_u32_u24 v73, v223, s35, v73
  v_mad_u32_u24 v74, v224, s35, v74
  v_mad_u32_u24 v75, v225, s35, v75
L_pfast_2:
  v_lshl_add_u32 v72, v52, 3, v72
  v_lshl_add_u32 v73, v53, 3, v73
  v_lshl_add_u32 v74, v54, 3, v74
  v_lshl_add_u32 v75, v55, 3, v75
  s_mov_b64 exec, s[72:73]
  ds_write_b64 v72, v[196:197] offset:8
  s_mov_b64 exec, s[74:75]
  ds_write_b64 v73, v[198:199] offset:8
  s_mov_b64 exec, s[76:77]
  ds_write_b64 v74, v[200:201] offset:8
  s_mov_b64 exec, s[78:79]
  ds_write_b64 v75, v[202:203] offset:8
  s_mov_b64 exec, -1
  v_max3_u32 v218, v56, v57, v58
  v_max_u32 v218, v218, v59
  v_cmp_lt_u32 vcc, 31, v218
  s_cbranch_vccz L_pfast_3
  v_cmp_lt_u32 vcc, 63, v218
  s_cbranch_vccnz L_pslow_3
L_pback_3:
  v_subrev_u32 v222, 31, v56
  v_subrev_u32 v223, 31, v57
  v_subrev_u32 v224, 31, v58
  v_subrev_u32 v225, 31, v59
  s_mov_b64 exec, s[80:81]
  ds_max_i32 v76, v222 offset:52800
  s_mov_b64 exec, s[82:83]
  ds_max_i32 v77, v223 offset:52800
  s_mov_b64 exec, s[84:85]
  ds_max_i32 v78, v224 offset:52800
  s_mov_b64 exec, s[86:87]
  ds_max_i32 v79, v225 offset:52800
  s_mov_b64 exec, -1
  ds_write_b32 v17, v11 offset:4
  v_lshrrev_b32 v222, 5, v56
  v_lshrrev_b32 v223, 5, v57
  v_lshrrev_b32 v224, 5, v58
  v_lshrrev_b32 v225, 5, v59
  v_mad_u32_u24 v76, v222, s35, v76
  v_mad_u32_u24 v77, v223, s35, v77
  v_mad_u32_u24 v78, v224, s35, v78
  v_mad_u32_u24 v79, v225, s35, v79
L_pfast_3:
  v_lshl_add_u32 v76, v56, 3, v76
  v_lshl_add_u32 v77, v57, 3, v77
  v_lshl_add_u32 v78, v58, 3, v78
  v_lshl_add_u32 v79, v59, 3, v79
  s_mov_b64 exec, s[80:81]
  ds_write_b64 v76, v[204:205] offset:8
  s_mov_b64 exec, s[82:83]
  ds_write_b64 v77, v[206:207] offset:8
  s_mov_b64 exec, s[84:85]
  ds_write_b64 v78, v[208:209] offset:8
  s_mov_b64 exec, s[86:87]
  ds_write_b64 v79, v[210:211] offset:8
  s_mov_b64 exec, -1
L_gen_done:
  s_lshr_b32 s45, s43, 5
  s_add_u32 s45, s45, 100
  s_mul_hi_u32 s45, s45, 61357
  v_cmp_ne_u32 vcc, 0, v33
  s_or_b32 s85, vcc_lo, vcc_hi
  s_branch L_turn2
.p2align 6
L_loop:
  ds_write_b16 v245, v240
  ds_read_b128 v[76:79], v5
  ds_write_b16 v245, v18
  ds_read_b64 v[216:217], v9 offset:272
  ds_write_b32 v9, v35 offset:12
  s_waitcnt vmcnt(4) lgkmcnt(5)
  v_mfma_f32_16x16x32_bf16 v[64:67], v[44:47], v[36:39], 0
  v_mfma_f32_16x16x32_bf16 v[68:71], v[44:47], v[40:43], 0
  v_and_or_b32 v219, v215, v35, v2
  v_mul_f32 v220, v214, v3
  v_and_b32 v221, 14, v215
  buffer_load_dwordx4 v[44:47], v219, s[4:7], 0 idxen
  v_cos_f32 v220, v220
  v_lshl_add_u32 v245, v221, 3, v4
  v_cvt_pk_bf16_f32 v240, v220, v220
  v_cmp_gt_u32 vcc, s40, v14
  s_add_u32 s41, s34, 2
  s_and_b32 s41, s41, 3
  s_lshl_b32 s41, s41, 3
  s_add_u32 s41, s41, 114688
  v_mov_b32 v219, s41
  ds_write_b64 v219, v[18:19]
  ds_write_b32 v10, v18
  v_lshlrev_b32 v218, 3, v14
  v_cndmask_b32 v218, v12, v218, vcc
  buffer_load_dwordx2 v[190:191], v218, s[12:15], s38 offen sc1
  s_cmp_lt_u32 s33, 4
  s_cbranch_scc1 L_lpprio0
  s_setprio 1
L_lpprio0:
  s_cmp_lg_u32 s85, 0
  v_add_u32_dpp v222, v32, v6 row_newbcast:0 row_mask:0xf bank_mask:0xf
  v_sub_u32_dpp v223, v34, v8 row_newbcast:0 row_mask:0xf bank_mask:0xf
  s_cbranch_scc1 L_two_0
L_two_back_0:
  v_bfi_b32 v222, v16, v222, v223
  buffer_load_dwordx2 v[180:181], v222, s[8:11], 0 offen sc1
  v_cvt_pk_bf16_f32 v72, v64, v65
  v_cvt_pk_bf16_f32 v73, v66, v67
  v_cvt_pk_bf16_f32 v74, v68, v69
  v_cvt_pk_bf16_f32 v75, v70, v71
  s_waitcnt lgkmcnt(3)
  s_nop 0
  v_mfma_f32_16x16x32_bf16 v[160:163], v[72:75], v[76:79], v[160:163]
  ds_write_b16 v246, v241
  ds_read_b128 v[76:79], v5
  ds_write_b16 v246, v18
  ds_read_b64 v[214:215], v9 offset:536
  ds_write_b32 v9, v35 offset:276
  s_waitcnt vmcnt(6) lgkmcnt(5)
  v_mfma_f32_16x16x32_bf16 v[64:67], v[48:51], v[36:39], 0
  v_mfma_f32_16x16x32_bf16 v[68:71], v[48:51], v[40:43], 0
  v_and_or_b32 v219, v217, v35, v2
  v_mul_f32 v220, v216, v3
  v_and_b32 v221, 14, v217
  buffer_load_dwordx4 v[48:51], v219, s[4:7], 0 idxen
  v_cos_f32 v220, v220
  v_lshl_add_u32 v246, v221, 3, v4
  v_cvt_pk_bf16_f32 v241, v220, v220
  s_cmp_lg_u32 s85, 0
  v_add_u32_dpp v222, v32, v6 row_newbcast:1 row_mask:0xf bank_mask:0xf
  v_sub_u32_dpp v223, v34, v8 row_newbcast:1 row_mask:0xf bank_mask:0xf
  s_cbranch_scc1 L_two_1
L_two_back_1:
  v_bfi_b32 v222, v16, v222, v223
  buffer_load_dwordx2 v[182:183], v222, s[8:11], 0 offen sc1
  v_cvt_pk_bf16_f32 v72, v64, v65
  v_cvt_pk_bf16_f32 v73, v66, v67
  v_cvt_pk_bf16_f32 v74, v68, v69
  v_cvt_pk_bf16_f32 v75, v70, v71
  s_waitcnt lgkmcnt(3)
  s_nop 0
  v_mfma_f32_16x16x32_bf16 v[164:167], v[72:75], v[76:79], v[164:167]
  ds_write_b16 v247, v242
  ds_read_b128 v[76:79], v5
  ds_write_b16 v247, v18
  ds_read_b64 v[216:217], v9 offset:800
  ds_write_b32 v9, v35 offset:540
  s_waitcnt vmcnt(7) lgkmcnt(5)
  v_mfma_f32_16x16x32_bf16 v[64:67], v[52:55], v[36:39], 0
  v_mfma_f32_16x16x32_bf16 v[68:71], v[52:55], v[40:43], 0
  v_and_or_b32 v219, v215, v35, v2
  v_mul_f32 v220, v214, v3
  v_and_b32 v221, 14, v215
  buffer_load_dwordx4 v[52:55], v219, s[4:7], 0 idxen
  v_cos_f32 v220, v220
  v_lshl_add_u32 v247, v221, 3, v4
  v_cvt_pk_bf16_f32 v242, v220, v220
  s_cmp_lg_u32 s85, 0
  v_add_u32_dpp v222, v32, v6 row_newbcast:2 row_mask:0xf bank_mask:0xf
  v_sub_u32_dpp v223, v34, v8 row_newbcast:2 row_mask:0xf bank_mask:0xf
  s_cbranch_scc1 L_two_2
L_two_back_2:
  v_bfi_b32 v222, v16, v222, v223
  buffer_load_dwordx2 v[184:185], v222, s[8:11], 0 offen sc1
  s_waitcnt vmcnt(4)
  v_cmp_gt_i32 vcc, 0, v180
  v_min_i32 v187, v180, v181
  v_cmp_gt_i32 s[72:73], s35, v187
  v_bfe_u32 v228, v187, 23, 8
  v_cndmask_b32_sdwa v186, v180, v181, vcc dst_sel:WORD_1 dst_unused:UNUSED_PAD src0_sel:WORD_1 src1_sel:WORD_0
  v_mad_u32_u24 v228, v228, v15, s36
  s_mov_b64 exec, s[72:73]
  ds_add_rtn_u32 v230, v228, v11
  s_mov_b64 exec, -1
  s_cmp_eq_u32 s34, 0
  s_cbranch_scc1 L_sig
L_nosig_b0:
  v_cvt_pk_bf16_f32 v72, v64, v65
  v_cvt_pk_bf16_f32 v73, v66, v67
  v_cvt_pk_bf16_f32 v74, v68, v69
  v_cvt_pk_bf16_f32 v75, v70, v71
  s_waitcnt lgkmcnt(3)
  s_nop 0
  v_mfma_f32_16x16x32_bf16 v[168:171], v[72:75], v[76:79], v[168:171]
  ds_write_b16 v248, v243
  ds_read_b128 v[76:79], v5
  ds_write_b16 v248, v18
  ds_read_b64 v[214:215], v9 offset:1064
  ds_write_b32 v9, v35 offset:804
  s_waitcnt vmcnt(8) lgkmcnt(5)
  v_mfma_f32_16x16x32_bf16 v[64:67], v[56:59], v[36:39], 0
  v_mfma_f32_16x16x32_bf16 v[68:71], v[56:59], v[40:43], 0
  v_and_or_b32 v219, v217, v35, v2
  v_mul_f32 v220, v216, v3
  v_and_b32 v221, 14, v217
  buffer_load_dwordx4 v[56:59], v219, s[4:7], 0 idxen
  v_cos_f32 v220, v220
  v_lshl_add_u32 v248, v221, 3, v4
  v_cvt_pk_bf16_f32 v243, v220, v220
  s_cmp_lg_u32 s85, 0
  v_add_u32_dpp v222, v32, v6 row_newbcast:3 row_mask:0xf bank_mask:0xf
  v_sub_u32_dpp v223, v34, v8 row_newbcast:3 row_mask:0xf bank_mask:0xf
  s_cbranch_scc1 L_two_3
L_two_back_3:
  v_bfi_b32 v222, v16, v222, v223
  buffer_load_dwordx2 v[180:181], v222, s[8:11], 0 offen sc1
  s_mov_b64 exec, s[72:73]
  v_cmp_lt_u32 vcc, 31, v230
  v_lshl_add_u32 v228, v230, 3, v228
  s_cbranch_vccnz L_rare_lp_0
L_back_lp_0:
  ds_write_b64 v228, v[186:187] offset:8
  s_mov_b64 exec, -1
  s_waitcnt vmcnt(4)
  v_cmp_gt_i32 vcc, 0, v182
  v_min_i32 v189, v182, v183
  v_cmp_gt_i32 s[74:75], s35, v189
  v_bfe_u32 v229, v189, 23, 8
  v_cndmask_b32_sdwa v188, v182, v183, vcc dst_sel:WORD_1 dst_unused:UNUSED_PAD src0_sel:WORD_1 src1_sel:WORD_0
  v_mad_u32_u24 v229, v229, v15, s36
  s_mov_b64 exec, s[74:75]
  ds_add_rtn_u32 v231, v229, v11
  s_mov_b64 exec, -1
  v_cvt_pk_bf16_f32 v72, v64, v65
  v_cvt_pk_bf16_f32 v73, v66, v67
  v_cvt_pk_bf16_f32 v74, v68, v69
  v_cvt_pk_bf16_f32 v75, v70, v71
  s_waitcnt lgkmcnt(3)
  s_nop 0
  v_mfma_f32_16x16x32_bf16 v[172:175], v[72:75], v[76:79], v[172:175]
  ds_write_b16 v249, v244
  ds_read_b128 v[76:79], v5
  ds_write_b16 v249, v18
  ds_read_b64 v[216:217], v9 offset:1328
  ds_write_b32 v9, v35 offset:1068
  s_waitcnt vmcnt(9) lgkmcnt(5)
  v_mfma_f32_16x16x32_bf16 v[64:67], v[60:63], v[36:39], 0
  v_mfma_f32_16x16x32_bf16 v[68:71], v[60:63], v[40:43], 0
  v_and_or_b32 v219, v215, v35, v2
  v_mul_f32 v220, v214, v3
  v_and_b32 v221, 14, v215
  buffer_load_dwordx4 v[60:63], v219, s[4:7], 0 idxen
  v_cos_f32 v220, v220
  v_lshl_add_u32 v249, v221, 3, v4
  v_cvt_pk_bf16_f32 v244, v220, v220
  s_cmp_lg_u32 s85, 0
  v_add_u32_dpp v222, v32, v6 row_newbcast:4 row_mask:0xf bank_mask:0xf
  v_sub_u32_dpp v223, v34, v8 row_newbcast:4 row_mask:0xf bank_mask:0xf
  s_cbranch_scc1 L_two_4
L_two_back_4:
  v_bfi_b32 v222, v16, v222, v223
  buffer_load_dwordx2 v[182:183], v222, s[8:11], 0 offen sc1
  s_mov_b64 exec, s[74:75]
  v_cmp_lt_u32 vcc, 31, v231
  v_lshl_add_u32 v229, v231, 3, v229
  s_cbranch_vccnz L_rare_lp_1
L_back_lp_1:
  ds_write_b64 v229, v[188:189] offset:8
  s_mov_b64 exec, -1
  s_waitcnt vmcnt(4)
  v_cmp_gt_i32 vcc, 0, v184
  v_min_i32 v187, v184, v185
  v_cmp_gt_i32 s[72:73], s35, v187
  v_bfe_u32 v228, v187, 23, 8
  v_cndmask_b32_sdwa v186, v184, v185, vcc dst_sel:WORD_1 dst_unused:UNUSED_PAD src0_sel:WORD_1 src1_sel:WORD_0
  v_mad_u32_u24 v228, v228, v15, s36
  s_mov_b64 exec, s[72:73]
  ds_add_rtn_u32 v230, v228, v11
  s_mov_b64 exec, -1
  v_cvt_pk_bf16_f32 v72, v64, v65
  v_cvt_pk_bf16_f32 v73, v66, v67
  v_cvt_pk_bf16_f32 v74, v68, v69
  v_cvt_pk_bf16_f32 v75, v70, v71
  s_waitcnt lgkmcnt(3)
  s_nop 0
  v_mfma_f32_16x16x32_bf16 v[176:179], v[72:75], v[76:79], v[176:179]
  ds_write_b16 v245, v240
  ds_read_b128 v[76:79], v5
  ds_write_b16 v245, v18
  ds_read_b64 v[214:215], v9 offset:1592
  ds_write_b32 v9, v35 offset:1332
  s_waitcnt vmcnt(10) lgkmcnt(5)
  v_mfma_f32_16x16x32_bf16 v[64:67], v[44:47], v[36:39], 0
  v_mfma_f32_16x16x32_bf16 v[68:71], v[44:47], v[40:43], 0
  v_and_or_b32 v219, v217, v35, v2
  v_mul_f32 v220, v216, v3
  v_and_b32 v221, 14, v217
  buffer_load_dwordx4 v[44:47], v219, s[4:7], 0 idxen
  v_cos_f32 v220, v220
  v_lshl_add_u32 v245, v221, 3, v4
  v_cvt_pk_bf16_f32 v240, v220, v220
  s_cmp_lg_u32 s85, 0
  v_add_u32_dpp v222, v32, v6 row_newbcast:5 row_mask:0xf bank_mask:0xf
  v_sub_u32_dpp v223, v34, v8 row_newbcast:5 row_mask:0xf bank_mask:0xf
  s_cbranch_scc1 L_two_5
L_two_back_5:
  v_bfi_b32 v222, v16, v222, v223
  buffer_load_dwordx2 v[184:185], v222, s[8:11], 0 offen sc1
  s_mov_b64 exec, s[72:73]
  v_cmp_lt_u32 vcc, 31, v230
  v_lshl_add_u32 v228, v230, 3, v228
  s_cbranch_vccnz L_rare_lp_2
L_back_lp_2:
  ds_write_b64 v228, v[186:187] offset:8
  s_mov_b64 exec, -1
  s_waitcnt vmcnt(4)
  v_cmp_gt_i32 vcc, 0, v180
  v_min_i32 v189, v180, v181
  v_cmp_gt_i32 s[74:75], s35, v189
  v_bfe_u32 v229, v189, 23, 8
  v_cndmask_b32_sdwa v188, v180, v181, vcc dst_sel:WORD_1 dst_unused:UNUSED_PAD src0_sel:WORD_1 src1_sel:WORD_0
  v_mad_u32_u24 v229, v229, v15, s36
  s_mov_b64 exec, s[74:75]
  ds_add_rtn_u32 v231, v229, v11
  s_mov_b64 exec, -1
  v_cvt_pk_bf16_f32 v72, v64, v65
  v_cvt_pk_bf16_f32 v73, v66, v67
  v_cvt_pk_bf16_f32 v74, v68, v69
  v_cvt_pk_bf16_f32 v75, v70, v71
  s_waitcnt lgkmcnt(3)
  s_nop 0
  v_mfma_f32_16x16x32_bf16 v[80:83], v[72:75], v[76:79], v[80:83]
  ds_write_b16 v246, v241
  ds_read_b128 v[76:79], v5
  ds_write_b16 v246, v18
  ds_read_b64 v[216:217], v9 offset:1856
  ds_write_b32 v9, v35 offset:1596
  s_waitcnt vmcnt(9) lgkmcnt(5)
  v_mfma_f32_16x16x32_bf16 v[64:67], v[48:51], v[36:39], 0
  v_mfma_f32_16x16x32_bf16 v[68:71], v[48:51], v[40:43], 0
  v_and_or_b32 v219, v215, v35, v2
  v_mul_f32 v220, v214, v3
  v_and_b32 v221, 14, v215
  buffer_load_dwordx4 v[48:51], v219, s[4:7], 0 idxen
  v_cos_f32 v220, v220
  v_lshl_add_u32 v246, v221, 3, v4
  v_cvt_pk_bf16_f32 v241, v220, v220
  s_cmp_lg_u32 s85, 0
  v_add_u32_dpp v222, v32, v6 row_newbcast:6 row_mask:0xf bank_mask:0xf
  v_sub_u32_dpp v223, v34, v8 row_newbcast:6 row_mask:0xf bank_mask:0xf
  s_cbranch_scc1 L_two_6
L_two_back_6:
  v_bfi_b32 v222, v16, v222, v223
  buffer_load_dwordx2 v[180:181], v222, s[8:11], 0 offen sc1
  s_mov_b64 exec, s[74:75]
  v_cmp_lt_u32 vcc, 31, v231
  v_lshl_add_u32 v229, v231, 3, v229
  s_cbranch_vccnz L_rare_lp_3
L_back_lp_3:
  ds_write_b64 v229, v[188:189] offset:8
  s_mov_b64 exec, -1
  s_waitcnt vmcnt(4)
  v_cmp_gt_i32 vcc, 0, v182
  v_min_i32 v187, v182, v183
  v_cmp_gt_i32 s[72:73], s35, v187
  v_bfe_u32 v228, v187, 23, 8
  v_cndmask_b32_sdwa v186, v182, v183, vcc dst_sel:WORD_1 dst_unused:UNUSED_PAD src0_sel:WORD_1 src1_sel:WORD_0
  v_mad_u32_u24 v228, v228, v15, s36
  s_mov_b64 exec, s[72:73]
  ds_add_rtn_u32 v230, v228, v11
  s_mov_b64 exec, -1
  v_cvt_pk_bf16_f32 v72, v64, v65
  v_cvt_pk_bf16_f32 v73, v66, v67
  v_cvt_pk_bf16_f32 v74, v68, v69
  v_cvt_pk_bf16_f32 v75, v70, v71
  s_waitcnt lgkmcnt(3)
  s_nop 0
  v_mfma_f32_16x16x32_bf16 v[84:87], v[72:75], v[76:79], v[84:87]
  ds_write_b16 v247, v242
  ds_read_b128 v[76:79], v5
  ds_write_b16 v247, v18
  ds_read_b64 v[214:215], v9 offset:2120
  ds_write_b32 v9, v35 offset:1860
  s_waitcnt vmcnt(9) lgkmcnt(5)
  v_mfma_f32_16x16x32_bf16 v[64:67], v[52:55], v[36:39], 0
  v_mfma_f32_16x16x32_bf16 v[68:71], v[52:55], v[40:43], 0
  v_and_or_b32 v219, v217, v35, v2
  v_mul_f32 v220, v216, v3
  v_and_b32 v221, 14, v217
  buffer_load_dwordx4 v[52:55], v219, s[4:7], 0 idxen
  v_cos_f32 v220, v220
  v_lshl_add_u32 v247, v221, 3, v4
  v_cvt_pk_bf16_f32 v242, v220, v220
  s_cmp_lg_u32 s85, 0
  v_add_u32_dpp v222, v32, v6 row_newbcast:7 row_mask:0xf bank_mask:0xf
  v_sub_u32_dpp v223, v34, v8 row_newbcast:7 row_mask:0xf bank_mask:0xf
  s_cbranch_scc1 L_two_7
L_two_back_7:
  v_bfi_b32 v222, v16, v222, v223
  buffer_load_dwordx2 v[182:183], v222, s[8:11], 0 offen sc1
  s_mov_b64 exec, s[72:73]
  v_cmp_lt_u32 vcc, 31, v230
  v_lshl_add_u32 v228, v230, 3, v228
  s_cbranch_vccnz L_rare_lp_4
L_back_lp_4:
  ds_write_b64 v228, v[186:187] offset:8
  s_mov_b64 exec, -1
  s_waitcnt vmcnt(4)
  v_cmp_gt_i32 vcc, 0, v184
  v_min_i32 v189, v184, v185
  v_cmp_gt_i32 s[74:75], s35, v189
  v_bfe_u32 v229, v189, 23, 8
  v_cndmask_b32_sdwa v188, v184, v185, vcc dst_sel:WORD_1 dst_unused:UNUSED_PAD src0_sel:WORD_1 src1_sel:WORD_0
  v_mad_u32_u24 v229, v229, v15, s36
  s_mov_b64 exec, s[74:75]
  ds_add_rtn_u32 v231, v229, v11
  s_mov_b64 exec, -1
  v_cvt_pk_bf16_f32 v72, v64, v65
  v_cvt_pk_bf16_f32 v73, v66, v67
  v_cvt_pk_bf16_f32 v74, v68, v69
  v_cvt_pk_bf16_f32 v75, v70, v71
  s_waitcnt lgkmcnt(3)
  s_nop 0
  v_mfma_f32_16x16x32_bf16 v[88:91], v[72:75], v[76:79], v[88:91]
  ds_write_b16 v248, v243
  ds_read_b128 v[76:79], v5
  ds_write_b16 v248, v18
  ds_read_b64 v[216:217], v9 offset:2384
  ds_write_b32 v9, v35 offset:2124
  s_waitcnt vmcnt(9) lgkmcnt(5)
  v_mfma_f32_16x16x32_bf16 v[64:67], v[56:59], v[36:39], 0
  v_mfma_f32_16x16x32_bf16 v[68:71], v[56:59], v[40:43], 0
  v_and_or_b32 v219, v215, v35, v2
  v_mul_f32 v220, v214, v3
  v_and_b32 v221, 14, v215
  buffer_load_dwordx4 v[56:59], v219, s[4:7], 0 idxen
  v_cos_f32 v220, v220
  v_lshl_add_u32 v248, v221, 3, v4
  v_cvt_pk_bf16_f32 v243, v220, v220
  s_cmp_lg_u32 s85, 0
  v_add_u32_dpp v222, v32, v6 row_newbcast:8 row_mask:0xf bank_mask:0xf
  v_sub_u32_dpp v223, v34, v8 row_newbcast:8 row_mask:0xf bank_mask:0xf
  s_cbranch_scc1 L_two_8
L_two_back_8:
  v_bfi_b32 v222, v16, v222, v223
  buffer_load_dwordx2 v[184:185], v222, s[8:11], 0 offen sc1
  s_mov_b64 exec, s[74:75]
  v_cmp_lt_u32 vcc, 31, v231
  v_lshl_add_u32 v229, v231, 3, v229
  s_cbranch_vccnz L_rare_lp_5
L_back_lp_5:
  ds_write_b64 v229, v[188:189] offset:8
  s_mov_b64 exec, -1
  s_waitcnt vmcnt(4)
  v_cmp_gt_i32 vcc, 0, v180
  v_min_i32 v187, v180, v181
  v_cmp_gt_i32 s[72:73], s35, v187
  v_bfe_u32 v228, v187, 23, 8
  v_cndmask_b32_sdwa v186, v180, v181, vcc dst_sel:WORD_1 dst_unused:UNUSED_PAD src0_sel:WORD_1 src1_sel:WORD_0
  v_mad_u32_u24 v228, v228, v15, s36
  s_mov_b64 exec, s[72:73]
  ds_add_rtn_u32 v230, v228, v11
  s_mov_b64 exec, -1
  v_cvt_pk_bf16_f32 v72, v64, v65
  v_cvt_pk_bf16_f32 v73, v66, v67
  v_cvt_pk_bf16_f32 v74, v68, v69
  v_cvt_pk_bf16_f32 v75, v70, v71
  s_waitcnt lgkmcnt(3)
  s_nop 0
  v_mfma_f32_16x16x32_bf16 v[92:95], v[72:75], v[76:79], v[92:95]
  ds_write_b16 v249, v244
  ds_read_b128 v[76:79], v5
  ds_write_b16 v249, v18
  ds_read_b64 v[214:215], v9 offset:2648
  ds_write_b32 v9, v35 offset:2388
  s_waitcnt vmcnt(9) lgkmcnt(5)
  v_mfma_f32_16x16x32_bf16 v[64:67], v[60:63], v[36:39], 0
  v_mfma_f32_16x16x32_bf16 v[68:71], v[60:63], v[40:43], 0
  v_and_or_b32 v219, v217, v35, v2
  v_mul_f32 v220, v216, v3
  v_and_b32 v221, 14, v217
  buffer_load_dwordx4 v[60:63], v219, s[4:7], 0 idxen
  v_cos_f32 v220, v220
  v_lshl_add_u32 v249, v221, 3, v4
  v_cvt_pk_bf16_f32 v244, v220, v220
  s_cmp_lg_u32 s85, 0
  v_add_u32_dpp v222, v32, v6 row_newbcast:9 row_mask:0xf bank_mask:0xf
  v_sub_u32_dpp v223, v34, v8 row_newbcast:9 row_mask:0xf bank_mask:0xf
  s_cbranch_scc1 L_two_9
L_two_back_9:
  v_bfi_b32 v222, v16, v222, v223
  buffer_load_dwordx2 v[180:181], v222, s[8:11], 0 offen sc1
  s_mov_b64 exec, s[72:73]
  v_cmp_lt_u32 vcc, 31, v230
  v_lshl_add_u32 v228, v230, 3, v228
  s_cbranch_vccnz L_rare_lp_6
L_back_lp_6:
  ds_write_b64 v228, v[186:187] offset:8
  s_mov_b64 exec, -1
  s_waitcnt vmcnt(4)
  v_cmp_gt_i32 vcc, 0, v182
  v_min_i32 v189, v182, v183
  v_cmp_gt_i32 s[74:75], s35, v189
  v_bfe_u32 v229, v189, 23, 8
  v_cndmask_b32_sdwa v188, v182, v183, vcc dst_sel:WORD_1 dst_unused:UNUSED_PAD src0_sel:WORD_1 src1_sel:WORD_0
  v_mad_u32_u24 v229, v229, v15, s36
  s_mov_b64 exec, s[74:75]
  ds_add_rtn_u32 v231, v229, v11
  s_mov_b64 exec, -1
  v_cvt_pk_bf16_f32 v72, v64, v65
  v_cvt_pk_bf16_f32 v73, v66, v67
  v_cvt_pk_bf16_f32 v74, v68, v69
  v_cvt_pk_bf16_f32 v75, v70, v71
  s_waitcnt lgkmcnt(3)
  s_nop 0
  v_mfma_f32_16x16x32_bf16 v[96:99], v[72:75], v[76:79], v[96:99]
  ds_write_b16 v245, v240
  ds_read_b128 v[76:79], v5
  ds_write_b16 v245, v18
  ds_read_b64 v[216:217], v9 offset:2912
  ds_write_b32 v9, v35 offset:2652
  s_waitcnt vmcnt(9) lgkmcnt(5)
  v_mfma_f32_16x16x32_bf16 v[64:67], v[44:47], v[36:39], 0
  v_mfma_f32_16x16x32_bf16 v[68:71], v[44:47], v[40:43], 0
  v_and_or_b32 v219, v215, v35, v2
  v_mul_f32 v220, v214, v3
  v_and_b32 v221, 14, v215
  buffer_load_dwordx4 v[44:47], v219, s[4:7], 0 idxen
  v_cos_f32 v220, v220
  v_lshl_add_u32 v245, v221, 3, v4
  v_cvt_pk_bf16_f32 v240, v220, v220
  s_cmp_lg_u32 s85, 0
  v_add_u32_dpp v222, v32, v6 row_newbcast:10 row_mask:0xf bank_mask:0xf
  v_sub_u32_dpp v223, v34, v8 row_newbcast:10 row_mask:0xf bank_mask:0xf
  s_cbranch_scc1 L_two_10
L_two_back_10:
  v_bfi_b32 v222, v16, v222, v223
  buffer_load_dwordx2 v[182:183], v222, s[8:11], 0 offen sc1
  s_mov_b64 exec, s[74:75]
  v_cmp_lt_u32 vcc, 31, v231
  v_lshl_add_u32 v229, v231, 3, v229
  s_cbranch_vccnz L_rare_lp_7
L_back_lp_7:
  ds_write_b64 v229, v[188:189] offset:8
  s_mov_b64 exec, -1
  s_waitcnt vmcnt(4)
  v_cmp_gt_i32 vcc, 0, v184
  v_min_i32 v187, v184, v185
  v_cmp_gt_i32 s[72:73], s35, v187
  v_bfe_u32 v228, v187, 23, 8
  v_cndmask_b32_sdwa v186, v184, v185, vcc dst_sel:WORD_1 dst_unused:UNUSED_PAD src0_sel:WORD_1 src1_sel:WORD_0
  v_mad_u32_u24 v228, v228, v15, s36
  s_mov_b64 exec, s[72:73]
  ds_add_rtn_u32 v230, v228, v11
  s_mov_b64 exec, -1
  v_cvt_pk_bf16_f32 v72, v64, v65
  v_cvt_pk_bf16_f32 v73, v66, v67
  v_cvt_pk_bf16_f32 v74, v68, v69
  v_cvt_pk_bf16_f32 v75, v70, v71
  s_waitcnt lgkmcnt(3)
  s_nop 0
  v_mfma_f32_16x16x32_bf16 v[100:103], v[72:75], v[76:79], v[100:103]
  ds_write_b16 v246, v241
  ds_read_b128 v[76:79], v5
  ds_write_b16 v246, v18
  ds_read_b64 v[214:215], v9 offset:3176
  ds_write_b32 v9, v35 offset:2916
  s_waitcnt vmcnt(9) lgkmcnt(5)
  v_mfma_f32_16x16x32_bf16 v[64:67], v[48:51], v[36:39], 0
  v_mfma_f32_16x16x32_bf16 v[68:71], v[48:51], v[40:43], 0
  v_and_or_b32 v219, v217, v35, v2
  v_mul_f32 v220, v216, v3
  v_and_b32 v221, 14, v217
  buffer_load_dwordx4 v[48:51], v219, s[4:7], 0 idxen
  v_cos_f32 v220, v220
  v_lshl_add_u32 v246, v221, 3, v4
  v_cvt_pk_bf16_f32 v241, v220, v220
  s_cmp_lg_u32 s85, 0
  v_add_u32_dpp v222, v32, v6 row_newbcast:11 row_mask:0xf bank_mask:0xf
  v_sub_u32_dpp v223, v34, v8 row_newbcast:11 row_mask:0xf bank_mask:0xf
  s_cbranch_scc1 L_two_11
L_two_back_11:
  v_bfi_b32 v222, v16, v222, v223
  buffer_load_dwordx2 v[184:185], v222, s[8:11], 0 offen sc1
  s_mov_b64 exec, s[72:73]
  v_cmp_lt_u32 vcc, 31, v230
  v_lshl_add_u32 v228, v230, 3, v228
  s_cbranch_vccnz L_rare_lp_8
L_back_lp_8:
  ds_write_b64 v228, v[186:187] offset:8
  s_mov_b64 exec, -1
  s_waitcnt vmcnt(4)
  v_cmp_gt_i32 vcc, 0, v180
  v_min_i32 v189, v180, v181
  v_cmp_gt_i32 s[74:75], s35, v189
  v_bfe_u32 v229, v189, 23, 8
  v_cndmask_b32_sdwa v188, v180, v181, vcc dst_sel:WORD_1 dst_unused:UNUSED_PAD src0_sel:WORD_1 src1_sel:WORD_0
  v_mad_u32_u24 v229, v229, v15, s36
  s_mov_b64 exec, s[74:75]
  ds_add_rtn_u32 v231, v229, v11
  s_mov_b64 exec, -1
  v_cvt_pk_bf16_f32 v72, v64, v65
  v_cvt_pk_bf16_f32 v73, v66, v67
  v_cvt_pk_bf16_f32 v74, v68, v69
  v_cvt_pk_bf16_f32 v75, v70, v71
  s_waitcnt lgkmcnt(3)
  s_nop 0
  v_mfma_f32_16x16x32_bf16 v[104:107], v[72:75], v[76:79], v[104:107]
  ds_write_b16 v247, v242
  ds_read_b128 v[76:79], v5
  ds_write_b16 v247, v18
  ds_read_b64 v[216:217], v9 offset:3440
  ds_write_b32 v9, v35 offset:3180
  s_waitcnt vmcnt(9) lgkmcnt(5)
  v_mfma_f32_16x16x32_bf16 v[64:67], v[52:55], v[36:39], 0
  v_mfma_f32_16x16x32_bf16 v[68:71], v[52:55], v[40:43], 0
  v_and_or_b32 v219, v215, v35, v2
  v_mul_f32 v220, v214, v3
  v_and_b32 v221, 14, v215
  buffer_load_dwordx4 v[52:55], v219, s[4:7], 0 idxen
  v_cos_f32 v220, v220
  v_lshl_add_u32 v247, v221, 3, v4
  v_cvt_pk_bf16_f32 v242, v220, v220
  s_setprio 0
  s_cmp_lg_u32 s85, 0
  v_add_u32_dpp v222, v32, v6 row_newbcast:12 row_mask:0xf bank_mask:0xf
  v_sub_u32_dpp v223, v34, v8 row_newbcast:12 row_mask:0xf bank_mask:0xf
  s_cbranch_scc1 L_two_12
L_two_back_12:
  v_bfi_b32 v222, v16, v222, v223
  buffer_load_dwordx2 v[180:181], v222, s[8:11], 0 offen sc1
  s_mov_b64 exec, s[74:75]
  v_cmp_lt_u32 vcc, 31, v231
  v_lshl_add_u32 v229, v231, 3, v229
  s_cbranch_vccnz L_rare_lp_9
L_back_lp_9:
  ds_write_b64 v229, v[188:189] offset:8
  s_mov_b64 exec, -1
  s_waitcnt vmcnt(4)
  v_cmp_gt_i32 vcc, 0, v182
  v_min_i32 v187, v182, v183
  v_cmp_gt_i32 s[72:73], s35, v187
  v_bfe_u32 v228, v187, 23, 8
  v_cndmask_b32_sdwa v186, v182, v183, vcc dst_sel:WORD_1 dst_unused:UNUSED_PAD src0_sel:WORD_1 src1_sel:WORD_0
  v_mad_u32_u24 v228, v228, v15, s36
  s_mov_b64 exec, s[72:73]
  ds_add_rtn_u32 v230, v228, v11
  s_mov_b64 exec, -1
  v_cvt_pk_bf16_f32 v72, v64, v65
  v_cvt_pk_bf16_f32 v73, v66, v67
  v_cvt_pk_bf16_f32 v74, v68, v69
  v_cvt_pk_bf16_f32 v75, v70, v71
  s_waitcnt lgkmcnt(3)
  s_nop 0
  v_mfma_f32_16x16x32_bf16 v[108:111], v[72:75], v[76:79], v[108:111]
  ds_write_b16 v248, v243
  ds_read_b128 v[76:79], v5
  ds_write_b16 v248, v18
  ds_read_b64 v[214:215], v9 offset:3704
  ds_write_b32 v9, v35 offset:3444
  s_waitcnt vmcnt(9) lgkmcnt(5)
  v_mfma_f32_16x16x32_bf16 v[64:67], v[56:59], v[36:39], 0
  v_mfma_f32_16x16x32_bf16 v[68:71], v[56:59], v[40:43], 0
  v_and_or_b32 v219, v217, v35, v2
  v_mul_f32 v220, v216, v3
  v_and_b32 v221, 14, v217
  buffer_load_dwordx4 v[56:59], v219, s[4:7], 0 idxen
  v_cos_f32 v220, v220
  v_lshl_add_u32 v248, v221, 3, v4
  v_cvt_pk_bf16_f32 v243, v220, v220
  s_cmp_lg_u32 s85, 0
  v_add_u32_dpp v222, v32, v6 row_newbcast:13 row_mask:0xf bank_mask:0xf
  v_sub_u32_dpp v223, v34, v8 row_newbcast:13 row_mask:0xf bank_mask:0xf
  s_cbranch_scc1 L_two_13
L_two_back_13:
  v_bfi_b32 v222, v16, v222, v223
  buffer_load_dwordx2 v[182:183], v222, s[8:11], 0 offen sc1
  s_mov_b64 exec, s[72:73]
  v_cmp_lt_u32 vcc, 31, v230
  v_lshl_add_u32 v228, v230, 3, v228
  s_cbranch_vccnz L_rare_lp_10
L_back_lp_10:
  ds_write_b64 v228, v[186:187] offset:8
  s_mov_b64 exec, -1
  s_waitcnt vmcnt(4)
  v_cmp_gt_i32 vcc, 0, v184
  v_min_i32 v189, v184, v185
  v_cmp_gt_i32 s[74:75], s35, v189
  v_bfe_u32 v229, v189, 23, 8
  v_cndmask_b32_sdwa v188, v184, v185, vcc dst_sel:WORD_1 dst_unused:UNUSED_PAD src0_sel:WORD_1 src1_sel:WORD_0
  v_mad_u32_u24 v229, v229, v15, s36
  s_mov_b64 exec, s[74:75]
  ds_add_rtn_u32 v231, v229, v11
  s_mov_b64 exec, -1
  v_cvt_pk_bf16_f32 v72, v64, v65
  v_cvt_pk_bf16_f32 v73, v66, v67
  v_cvt_pk_bf16_f32 v74, v68, v69
  v_cvt_pk_bf16_f32 v75, v70, v71
  s_waitcnt lgkmcnt(3)
  s_nop 0
  v_mfma_f32_16x16x32_bf16 v[112:115], v[72:75], v[76:79], v[112:115]
  ds_write_b16 v249, v244
  ds_read_b128 v[76:79], v5
  ds_write_b16 v249, v18
  ds_read_b64 v[216:217], v9 offset:3968
  ds_write_b32 v9, v35 offset:3708
  s_waitcnt vmcnt(9) lgkmcnt(5)
  v_mfma_f32_16x16x32_bf16 v[64:67], v[60:63], v[36:39], 0
  v_mfma_f32_16x16x32_bf16 v[68:71], v[60:63], v[40:43], 0
  v_and_or_b32 v219, v215, v35, v2
  v_mul_f32 v220, v214, v3
  v_and_b32 v221, 14, v215
  buffer_load_dwordx4 v[60:63], v219, s[4:7], 0 idxen
  v_cos_f32 v220, v220
  v_lshl_add_u32 v249, v221, 3, v4
  v_cvt_pk_bf16_f32 v244, v220, v220
  s_cmp_lg_u32 s85, 0
  v_add_u32_dpp v222, v32, v6 row_newbcast:14 row_mask:0xf bank_mask:0xf
  v_sub_u32_dpp v223, v34, v8 row_newbcast:14 row_mask:0xf bank_mask:0xf
  s_cbranch_scc1 L_two_14
L_two_back_14:
  v_bfi_b32 v222, v16, v222, v223
  buffer_load_dwordx2 v[184:185], v222, s[8:11], 0 offen sc1
  s_mov_b64 exec, s[74:75]
  v_cmp_lt_u32 vcc, 31, v231
  v_lshl_add_u32 v229, v231, 3, v229
  s_cbranch_vccnz L_rare_lp_11
L_back_lp_11:
  ds_write_b64 v229, v[188:189] offset:8
  s_mov_b64 exec, -1
  s_waitcnt vmcnt(4)
  v_cmp_gt_i32 vcc, 0, v180
  v_min_i32 v187, v180, v181
  v_cmp_gt_i32 s[72:73], s35, v187
  v_bfe_u32 v228, v187, 23, 8
  v_cndmask_b32_sdwa v186, v180, v181, vcc dst_sel:WORD_1 dst_unused:UNUSED_PAD src0_sel:WORD_1 src1_sel:WORD_0
  v_mad_u32_u24 v228, v228, v15, s36
  s_mov_b64 exec, s[72:73]
  ds_add_rtn_u32 v230, v228, v11
  s_mov_b64 exec, -1
  v_cvt_pk_bf16_f32 v72, v64, v65
  v_cvt_pk_bf16_f32 v73, v66, v67
  v_cvt_pk_bf16_f32 v74, v68, v69
  v_cvt_pk_bf16_f32 v75, v70, v71
  s_waitcnt lgkmcnt(3)
  s_nop 0
  v_mfma_f32_16x16x32_bf16 v[116:119], v[72:75], v[76:79], v[116:119]
  ds_write_b16 v245, v240
  ds_read_b128 v[76:79], v5
  ds_write_b16 v245, v18
  ds_read_b64 v[214:215], v9 offset:4232
  ds_write_b32 v9, v35 offset:3972
  s_waitcnt vmcnt(9) lgkmcnt(5)
  v_mfma_f32_16x16x32_bf16 v[64:67], v[44:47], v[36:39], 0
  v_mfma_f32_16x16x32_bf16 v[68:71], v[44:47], v[40:43], 0
  v_and_or_b32 v219, v217, v35, v2
  v_mul_f32 v220, v216, v3
  v_and_b32 v221, 14, v217
  buffer_load_dwordx4 v[44:47], v219, s[4:7], 0 idxen
  v_cos_f32 v220, v220
  v_lshl_add_u32 v245, v221, 3, v4
  v_cvt_pk_bf16_f32 v240, v220, v220
  s_cmp_lg_u32 s85, 0
  v_add_u32_dpp v222, v32, v6 row_newbcast:15 row_mask:0xf bank_mask:0xf
  v_sub_u32_dpp v223, v34, v8 row_newbcast:15 row_mask:0xf bank_mask:0xf
  s_cbranch_scc1 L_two_15
L_two_back_15:
  v_bfi_b32 v222, v16, v222, v223
  buffer_load_dwordx2 v[180:181], v222, s[8:11], 0 offen sc1
  s_mov_b64 exec, s[72:73]
  v_cmp_lt_u32 vcc, 31, v230
  v_lshl_add_u32 v228, v230, 3, v228
  s_cbranch_vccnz L_rare_lp_12
L_back_lp_12:
  ds_write_b64 v228, v[186:187] offset:8
  s_mov_b64 exec, -1
  s_waitcnt vmcnt(4)
  v_cmp_gt_i32 vcc, 0, v182
  v_min_i32 v189, v182, v183
  v_cmp_gt_i32 s[74:75], s35, v189
  v_bfe_u32 v229, v189, 23, 8
  v_cndmask_b32_sdwa v188, v182, v183, vcc dst_sel:WORD_1 dst_unused:UNUSED_PAD src0_sel:WORD_1 src1_sel:WORD_0
  v_mad_u32_u24 v229, v229, v15, s36
  s_mov_b64 exec, s[74:75]
  ds_add_rtn_u32 v231, v229, v11
  s_mov_b64 exec, -1
  v_cvt_pk_bf16_f32 v72, v64, v65
  v_cvt_pk_bf16_f32 v73, v66, v67
  v_cvt_pk_bf16_f32 v74, v68, v69
  v_cvt_pk_bf16_f32 v75, v70, v71
  s_waitcnt lgkmcnt(3)
  s_nop 0
  v_mfma_f32_16x16x32_bf16 v[120:123], v[72:75], v[76:79], v[120:123]
  ds_write_b16 v246, v241
  ds_read_b128 v[76:79], v5
  ds_write_b16 v246, v18
  ds_read_b64 v[216:217], v9 offset:4496
  ds_write_b32 v9, v35 offset:4236
  s_waitcnt vmcnt(9) lgkmcnt(5)
  v_mfma_f32_16x16x32_bf16 v[64:67], v[48:51], v[36:39], 0
  v_mfma_f32_16x16x32_bf16 v[68:71], v[48:51], v[40:43], 0
  v_and_or_b32 v219, v215, v35, v2
  v_mul_f32 v220, v214, v3
  v_and_b32 v221, 14, v215
  buffer_load_dwordx4 v[48:51], v219, s[4:7], 0 idxen
  v_cos_f32 v220, v220
  v_lshl_add_u32 v246, v221, 3, v4
  v_cvt_pk_bf16_f32 v241, v220, v220
  s_cmp_lg_u32 s35, 0
  s_cbranch_scc1 L_nostate
  s_cmp_eq_u32 s34, 0
  s_cbranch_scc1 L_borrow
L_borrow_back:
  v_sub_u32 v29, v29, v30
  v_lshrrev_b32 v218, 16, v20
  v_and_b32 v219, 0xffff, v20
  v_min_u32 v33, 32, v27
  v_cmp_ge_u32 vcc, 32, v27
  v_sub_u32 v220, 32, v33
  v_add_u32 v32, v28, v219
  v_min_u32 v220, v218, v220
  v_mul_u32_u24 v32, 6, v32
  v_add_u32 v30, v33, v220
  v_mad_i32_i24 v32, v33, -6, v32
  v_lshlrev_b32 v34, 2, v30
  v_add_u32 v31, v28, v26
  v_mul_u32_u24 v31, 6, v31
  v_add_u32 v26, 32, v26
  v_subrev_u32 v27, 32, v27
  v_add_u32 v219, v219, v220
  v_sub_u32 v218, v218, v220
  v_cndmask_b32 v26, v26, v219, vcc
  v_cndmask_b32 v27, v27, v218, vcc
  v_cndmask_b32 v20, v20, v21, vcc
  v_cndmask_b32 v21, v21, v22, vcc
  v_cndmask_b32 v22, v22, v23, vcc
  v_cndmask_b32 v23, v23, v24, vcc
  v_cndmask_b32 v24, v24, v25, vcc
  v_cndmask_b32 v25, v25, v18, vcc
  v_cmp_ne_u32 vcc, 0, v33
  s_or_b32 s85, vcc_lo, vcc_hi
L_nostate:
  v_cmp_lt_u32 vcc, 0, v29
  s_cbranch_vccz L_noflag_lp
  ds_write_b32 v17, v11 offset:4
L_noflag_lp:
  s_mov_b64 exec, s[74:75]
  v_cmp_lt_u32 vcc, 31, v231
  v_lshl_add_u32 v229, v231, 3, v229
  s_cbranch_vccnz L_rare_lp_13
L_back_lp_13:
  ds_write_b64 v229, v[188:189] offset:8
  s_mov_b64 exec, -1
  s_waitcnt vmcnt(3)
  v_cmp_gt_i32 vcc, 0, v184
  v_min_i32 v187, v184, v185
  v_cmp_gt_i32 s[72:73], s35, v187
  v_bfe_u32 v228, v187, 23, 8
  v_cndmask_b32_sdwa v186, v184, v185, vcc dst_sel:WORD_1 dst_unused:UNUSED_PAD src0_sel:WORD_1 src1_sel:WORD_0
  v_mad_u32_u24 v228, v228, v15, s36
  s_mov_b64 exec, s[72:73]
  ds_add_rtn_u32 v230, v228, v11
  s_mov_b64 exec, -1
  v_cvt_pk_bf16_f32 v72, v64, v65
  v_cvt_pk_bf16_f32 v73, v66, v67
  v_cvt_pk_bf16_f32 v74, v68, v69
  v_cvt_pk_bf16_f32 v75, v70, v71
  s_waitcnt lgkmcnt(3)
  s_nop 0
  v_mfma_f32_16x16x32_bf16 v[124:127], v[72:75], v[76:79], v[124:127]
  ds_write_b16 v247, v242
  ds_read_b128 v[76:79], v5
  ds_write_b16 v247, v18
  ds_read_b64 v[214:215], v9 offset:4760
  ds_write_b32 v9, v35 offset:4500
  s_waitcnt vmcnt(8) lgkmcnt(5)
  v_mfma_f32_16x16x32_bf16 v[64:67], v[52:55], v[36:39], 0
  v_mfma_f32_16x16x32_bf16 v[68:71], v[52:55], v[40:43], 0
  v_and_or_b32 v219, v217, v35, v2
  v_mul_f32 v220, v216, v3
  v_and_b32 v221, 14, v217
  buffer_load_dwordx4 v[52:55], v219, s[4:7], 0 idxen
  v_cos_f32 v220, v220
  v_lshl_add_u32 v247, v221, 3, v4
  v_cvt_pk_bf16_f32 v242, v220, v220
  s_mov_b64 exec, s[72:73]
  v_cmp_lt_u32 vcc, 31, v230
  v_lshl_add_u32 v228, v230, 3, v228
  s_cbranch_vccnz L_rare_lp_14
L_back_lp_14:
  ds_write_b64 v228, v[186:187] offset:8
  s_mov_b64 exec, -1
  s_waitcnt vmcnt(2)
  v_cmp_gt_i32 vcc, 0, v180
  v_min_i32 v189, v180, v181
  v_cmp_gt_i32 s[74:75], s35, v189
  v_bfe_u32 v229, v189, 23, 8
  v_cndmask_b32_sdwa v188, v180, v181, vcc dst_sel:WORD_1 dst_unused:UNUSED_PAD src0_sel:WORD_1 src1_sel:WORD_0
  v_mad_u32_u24 v229, v229, v15, s36
  s_mov_b64 exec, s[74:75]
  ds_add_rtn_u32 v231, v229, v11
  s_mov_b64 exec, -1
  v_cvt_pk_bf16_f32 v72, v64, v65
  v_cvt_pk_bf16_f32 v73, v66, v67
  v_cvt_pk_bf16_f32 v74, v68, v69
  v_cvt_pk_bf16_f32 v75, v70, v71
  s_waitcnt lgkmcnt(3)
  s_nop 0
  v_mfma_f32_16x16x32_bf16 v[128:131], v[72:75], v[76:79], v[128:131]
  ds_write_b16 v248, v243
  ds_read_b128 v[76:79], v5
  ds_write_b16 v248, v18
  ds_read_b64 v[216:217], v9 offset:5024
  ds_write_b32 v9, v35 offset:4764
  s_waitcnt vmcnt(7) lgkmcnt(5)
  v_mfma_f32_16x16x32_bf16 v[64:67], v[56:59], v[36:39], 0
  v_mfma_f32_16x16x32_bf16 v[68:71], v[56:59], v[40:43], 0
  v_and_or_b32 v219, v215, v35, v2
  v_mul_f32 v220, v214, v3
  v_and_b32 v221, 14, v215
  buffer_load_dwordx4 v[56:59], v219, s[4:7], 0 idxen
  v_cos_f32 v220, v220
  v_lshl_add_u32 v248, v221, 3, v4
  v_cvt_pk_bf16_f32 v243, v220, v220
  s_mov_b64 exec, s[74:75]
  v_cmp_lt_u32 vcc, 31, v231
  v_lshl_add_u32 v229, v231, 3, v229
  s_cbranch_vccnz L_rare_lp_15
L_back_lp_15:
  ds_write_b64 v229, v[188:189] offset:8
  s_mov_b64 exec, -1
  s_waitcnt vmcnt(34)
  v_cmp_gt_i32 vcc, 0, v190
  v_min_i32 v187, v190, v191
  v_cmp_gt_i32 s[72:73], 0, v187
  v_bfe_u32 v228, v187, 23, 8
  v_cndmask_b32_sdwa v186, v190, v191, vcc dst_sel:WORD_1 dst_unused:UNUSED_PAD src0_sel:WORD_1 src1_sel:WORD_0
  v_mad_u32_u24 v228, v228, v15, s36
  s_mov_b64 exec, s[72:73]
  ds_add_rtn_u32 v230, v228, v11
  s_mov_b64 exec, -1
  s_cmp_eq_u32 s34, s45
  s_cbranch_scc1 L_mld
L_mld_back1:
  v_cvt_pk_bf16_f32 v72, v64, v65
  v_cvt_pk_bf16_f32 v73, v66, v67
  v_cvt_pk_bf16_f32 v74, v68, v69
  v_cvt_pk_bf16_f32 v75, v70, v71
  s_waitcnt lgkmcnt(3)
  s_nop 0
  v_mfma_f32_16x16x32_bf16 v[132:135], v[72:75], v[76:79], v[132:135]
  ds_write_b16 v249, v244
  ds_read_b128 v[76:79], v5
  ds_write_b16 v249, v18
  ds_read_b64 v[214:215], v9 offset:5288
  ds_write_b32 v9, v35 offset:5028
  s_waitcnt vmcnt(6) lgkmcnt(5)
  v_mfma_f32_16x16x32_bf16 v[64:67], v[60:63], v[36:39], 0
  v_mfma_f32_16x16x32_bf16 v[68:71], v[60:63], v[40:43], 0
  v_and_or_b32 v219, v217, v35, v2
  v_mul_f32 v220, v216, v3
  v_and_b32 v221, 14, v217
  buffer_load_dwordx4 v[60:63], v219, s[4:7], 0 idxen
  v_cos_f32 v220, v220
  v_lshl_add_u32 v249, v221, 3, v4
  v_cvt_pk_bf16_f32 v244, v220, v220
  s_mov_b64 exec, s[72:73]
  v_cmp_lt_u32 vcc, 31, v230
  v_lshl_add_u32 v228, v230, 3, v228
  s_cbranch_vccnz L_rare_lp_16
L_back_lp_16:
  ds_write_b64 v228, v[186:187] offset:8
  s_mov_b64 exec, -1
  v_cvt_pk_bf16_f32 v72, v64, v65
  v_cvt_pk_bf16_f32 v73, v66, v67
  v_cvt_pk_bf16_f32 v74, v68, v69
  v_cvt_pk_bf16_f32 v75, v70, v71
  s_waitcnt lgkmcnt(3)
  s_nop 0
  v_mfma_f32_16x16x32_bf16 v[136:139], v[72:75], v[76:79], v[136:139]
  ds_write_b16 v245, v240
  ds_read_b128 v[76:79], v5
  ds_write_b16 v245, v18
  ds_read_b64 v[216:217], v9 offset:5552
  ds_write_b32 v9, v35 offset:5292
  s_waitcnt vmcnt(5) lgkmcnt(5)
  v_mfma_f32_16x16x32_bf16 v[64:67], v[44:47], v[36:39], 0
  v_mfma_f32_16x16x32_bf16 v[68:71], v[44:47], v[40:43], 0
  v_and_or_b32 v219, v215, v35, v2
  v_mul_f32 v220, v214, v3
  v_and_b32 v221, 14, v215
  buffer_load_dwordx4 v[44:47], v219, s[4:7], 0 idxen
  v_cos_f32 v220, v220
  v_lshl_add_u32 v245, v221, 3, v4
  v_cvt_pk_bf16_f32 v240, v220, v220
  s_cmp_gt_u32 s40, 512
  s_cbranch_scc1 L_slow_lp
L_slow_back_lp:
  s_or_b32 s41, s34, s33
  s_cbranch_scc0 L_ldc
L_ldc_back:
  v_cvt_pk_bf16_f32 v72, v64, v65
  v_cvt_pk_bf16_f32 v73, v66, v67
  v_cvt_pk_bf16_f32 v74, v68, v69
  v_cvt_pk_bf16_f32 v75, v70, v71
  s_waitcnt lgkmcnt(3)
  s_nop 0
  v_mfma_f32_16x16x32_bf16 v[140:143], v[72:75], v[76:79], v[140:143]
  ds_write_b16 v246, v241
  ds_read_b128 v[76:79], v5
  ds_write_b16 v246, v18
  ds_read_b64 v[214:215], v9 offset:5816
  ds_write_b32 v9, v35 offset:5556
  s_waitcnt vmcnt(4) lgkmcnt(5)
  v_mfma_f32_16x16x32_bf16 v[64:67], v[48:51], v[36:39], 0
  v_mfma_f32_16x16x32_bf16 v[68:71], v[48:51], v[40:43], 0
  v_and_or_b32 v219, v217, v35, v2
  v_mul_f32 v220, v216, v3
  v_and_b32 v221, 14, v217
  buffer_load_dwordx4 v[48:51], v219, s[4:7], 0 idxen
  v_cos_f32 v220, v220
  v_lshl_add_u32 v246, v221, 3, v4
  v_cvt_pk_bf16_f32 v241, v220, v220
  v_cvt_pk_bf16_f32 v72, v64, v65
  v_cvt_pk_bf16_f32 v73, v66, v67
  v_cvt_pk_bf16_f32 v74, v68, v69
  v_cvt_pk_bf16_f32 v75, v70, v71
  s_waitcnt lgkmcnt(3)
  s_nop 0
  v_mfma_f32_16x16x32_bf16 v[144:147], v[72:75], v[76:79], v[144:147]
  ds_write_b16 v247, v242
  ds_read_b128 v[76:79], v5
  ds_write_b16 v247, v18
  ds_read_b64 v[216:217], v9 offset:6080
  ds_write_b32 v9, v35 offset:5820
  s_waitcnt vmcnt(4) lgkmcnt(5)
  v_mfma_f32_16x16x32_bf16 v[64:67], v[52:55], v[36:39], 0
  v_mfma_f32_16x16x32_bf16 v[68:71], v[52:55], v[40:43], 0
  v_and_or_b32 v219, v215, v35, v2
  v_mul_f32 v220, v214, v3
  v_and_b32 v221, 14, v215
  buffer_load_dwordx4 v[52:55], v219, s[4:7], 0 idxen
  v_cos_f32 v220, v220
  v_lshl_add_u32 v247, v221, 3, v4
  v_cvt_pk_bf16_f32 v242, v220, v220
  v_cvt_pk_bf16_f32 v72, v64, v65
  v_cvt_pk_bf16_f32 v73, v66, v67
  v_cvt_pk_bf16_f32 v74, v68, v69
  v_cvt_pk_bf16_f32 v75, v70, v71
  s_waitcnt lgkmcnt(3)
  s_nop 0
  v_mfma_f32_16x16x32_bf16 v[148:151], v[72:75], v[76:79], v[148:151]
  ds_write_b16 v248, v243
  ds_read_b128 v[76:79], v5
  ds_write_b16 v248, v18
  ds_read_b64 v[214:215], v9 offset:6344
  ds_write_b32 v9, v35 offset:6084
  s_waitcnt vmcnt(4) lgkmcnt(5)
  v_mfma_f32_16x16x32_bf16 v[64:67], v[56:59], v[36:39], 0
  v_mfma_f32_16x16x32_bf16 v[68:71], v[56:59], v[40:43], 0
  v_and_or_b32 v219, v217, v35, v2
  v_mul_f32 v220, v216, v3
  v_and_b32 v221, 14, v217
  buffer_load_dwordx4 v[56:59], v219, s[4:7], 0 idxen
  v_cos_f32 v220, v220
  v_lshl_add_u32 v248, v221, 3, v4
  v_cvt_pk_bf16_f32 v243, v220, v220
  v_cvt_pk_bf16_f32 v72, v64, v65
  v_cvt_pk_bf16_f32 v73, v66, v67
  v_cvt_pk_bf16_f32 v74, v68, v69
  v_cvt_pk_bf16_f32 v75, v70, v71
  s_waitcnt lgkmcnt(3)
  s_nop 0
  v_mfma_f32_16x16x32_bf16 v[152:155], v[72:75], v[76:79], v[152:155]
  ds_write_b16 v249, v244
  ds_read_b128 v[76:79], v5
  ds_write_b16 v249, v18
  ds_write_b32 v9, v35 offset:6348
  s_waitcnt vmcnt(4) lgkmcnt(4)
  v_mfma_f32_16x16x32_bf16 v[64:67], v[60:63], v[36:39], 0
  v_mfma_f32_16x16x32_bf16 v[68:71], v[60:63], v[40:43], 0
  v_and_or_b32 v219, v215, v35, v2
  v_mul_f32 v220, v214, v3
  v_and_b32 v221, 14, v215
  buffer_load_dwordx4 v[60:63], v219, s[4:7], 0 idxen
  v_cos_f32 v220, v220
  v_lshl_add_u32 v249, v221, 3, v4
  v_cvt_pk_bf16_f32 v244, v220, v220
  v_cvt_pk_bf16_f32 v72, v64, v65
  v_cvt_pk_bf16_f32 v73, v66, v67
  v_cvt_pk_bf16_f32 v74, v68, v69
  v_cvt_pk_bf16_f32 v75, v70, v71
  s_waitcnt lgkmcnt(2)
  s_nop 0
  v_mfma_f32_16x16x32_bf16 v[156:159], v[72:75], v[76:79], v[156:159]
  s_waitcnt vmcnt(5)
  s_or_b32 s41, s34, s33
  s_cbranch_scc0 L_chkc
L_turn2:
  v_mov_b32 v218, v17
  s_add_u32 s34, s34, 1
  s_add_u32 s41, s34, 1
  s_and_b32 s41, s41, 3
  s_lshl_b32 s41, s41, 3
  s_add_u32 s41, s41, 114688
  v_mov_b32 v17, s41
  s_sub_u32 s41, s36, 52800
  s_add_u32 s41, s41, s36
  v_add_u32 v9, s41, v9
  v_add_u32 v10, s41, v10
  s_sub_u32 s36, 52800, s36
  s_mov_b32 s38, s37
  s_sub_u32 s37, 73728, s37
  s_waitcnt lgkmcnt(0)
  s_barrier
  ds_read_b64 v[220:221], v218
  ds_read_b64 v[214:215], v9 offset:8
  s_waitcnt lgkmcnt(1)
  v_readfirstlane_b32 s40, v220
  v_readfirstlane_b32 s42, v221
  s_cmp_gt_u32 s40, 512
  s_cselect_b32 s35, 0x80000000, 0
  s_min_u32 s40, s40, 9216
  s_cmp_gt_u32 s40, 32
  s_cselect_b32 s42, 1, s42
  s_cmp_lt_u32 s34, 400000
  s_cselect_b32 s42, s42, 0
  s_cmp_lg_u32 s42, 0
  s_cbranch_scc1 L_loop
  s_cmp_eq_u32 s34, 0
  s_cbranch_scc1 L_it0
L_nosig_z:
  v_and_b32 v218, 63, v0
  s_mul_i32 s41, s33, 3584
  s_add_u32 s41, s41, 114816
  v_lshl_add_u32 v219, v218, 3, s41
  v_lshlrev_b32 v6, 4, v218
  v_bfe_u32 v220, v0, 4, 2
  v_and_b32 v221, 15, v0
  v_lshlrev_b32 v220, 3, v220
  v_lshl_add_u32 v14, v221, 5, v220
  s_mul_i32 s41, s33, 6400
  s_add_u32 s41, s41, s36
  s_add_u32 s41, s41, 15
  s_and_b32 s41, s41, -16
  v_add_u32 v7, s41, v14
  v_add_u32 v8, s41, v6
  v_cmp_gt_u32 s[76:77], 8, v221
  ds_read_b64 v[20:21], v219 offset:0
  ds_read_b64 v[22:23], v219 offset:512
  ds_read_b64 v[24:25], v219 offset:1024
  ds_read_b64 v[26:27], v219 offset:1536
  ds_read_b64 v[28:29], v219 offset:2048
  ds_read_b64 v[30:31], v219 offset:2560
  ds_read_b64 v[32:33], v219 offset:3072
  ds_write_b16 v245, v240
  ds_read_b128 v[76:79], v5
  ds_write_b16 v245, v18
  ds_read_b64 v[216:217], v9 offset:272
  s_waitcnt vmcnt(4) lgkmcnt(4)
  v_mfma_f32_16x16x32_bf16 v[64:67], v[44:47], v[36:39], 0
  v_mfma_f32_16x16x32_bf16 v[68:71], v[44:47], v[40:43], 0
  v_and_or_b32 v219, v215, v35, v2
  v_mul_f32 v220, v214, v3
  v_and_b32 v221, 14, v215
  buffer_load_dwordx4 v[44:47], v219, s[4:7], 0 idxen
  v_cos_f32 v220, v220
  v_lshl_add_u32 v245, v221, 3, v4
  v_cvt_pk_bf16_f32 v240, v220, v220
  s_cmp_lt_u32 s33, 4
  s_cbranch_scc1 L_fpprio0
  s_setprio 1
L_fpprio0:
  s_cmp_lg_u32 s40, 0
  s_cbranch_scc1 L_x1
L_x1_back:
  v_cvt_pk_bf16_f32 v72, v64, v65
  v_cvt_pk_bf16_f32 v73, v66, v67
  v_cvt_pk_bf16_f32 v74, v68, v69
  v_cvt_pk_bf16_f32 v75, v70, v71
  s_waitcnt lgkmcnt(2)
  s_nop 0
  v_mfma_f32_16x16x32_bf16 v[160:163], v[72:75], v[76:79], v[160:163]
  ds_write_b16 v246, v241
  ds_read_b128 v[76:79], v5
  ds_write_b16 v246, v18
  ds_read_b64 v[214:215], v9 offset:536
  s_waitcnt vmcnt(4) lgkmcnt(4)
  v_mfma_f32_16x16x32_bf16 v[64:67], v[48:51], v[36:39], 0
  v_mfma_f32_16x16x32_bf16 v[68:71], v[48:51], v[40:43], 0
  v_and_or_b32 v219, v217, v35, v2
  v_mul_f32 v220, v216, v3
  v_and_b32 v221, 14, v217
  buffer_load_dwordx4 v[48:51], v219, s[4:7], 0 idxen
  v_cos_f32 v220, v220
  v_lshl_add_u32 v246, v221, 3, v4
  v_cvt_pk_bf16_f32 v241, v220, v220
  v_cvt_pk_bf16_f32 v72, v64, v65
  v_cvt_pk_bf16_f32 v73, v66, v67
  v_cvt_pk_bf16_f32 v74, v68, v69
  v_cvt_pk_bf16_f32 v75, v70, v71
  s_waitcnt lgkmcnt(2)
  s_nop 0
  v_mfma_f32_16x16x32_bf16 v[164:167], v[72:75], v[76:79], v[164:167]
  ds_write_b16 v247, v242
  ds_read_b128 v[76:79], v5
  ds_write_b16 v247, v18
  ds_read_b64 v[216:217], v9 offset:800
  s_waitcnt vmcnt(4) lgkmcnt(4)
  v_mfma_f32_16x16x32_bf16 v[64:67], v[52:55], v[36:39], 0
  v_mfma_f32_16x16x32_bf16 v[68:71], v[52:55], v[40:43], 0
  v_and_or_b32 v219, v215, v35, v2
  v_mul_f32 v220, v214, v3
  v_and_b32 v221, 14, v215
  buffer_load_dwordx4 v[52:55], v219, s[4:7], 0 idxen
  v_cos_f32 v220, v220
  v_lshl_add_u32 v247, v221, 3, v4
  v_cvt_pk_bf16_f32 v242, v220, v220
  s_cmp_ge_u32 s45, s34
  s_mov_b32 s45, -1
  s_cbranch_scc1 L_mld
L_mld_back2:
  v_cvt_pk_bf16_f32 v72, v64, v65
  v_cvt_pk_bf16_f32 v73, v66, v67
  v_cvt_pk_bf16_f32 v74, v68, v69
  v_cvt_pk_bf16_f32 v75, v70, v71
  s_waitcnt lgkmcnt(2)
  s_nop 0
  v_mfma_f32_16x16x32_bf16 v[168:171], v[72:75], v[76:79], v[168:171]
  ds_write_b16 v248, v243
  ds_read_b128 v[76:79], v5
  ds_write_b16 v248, v18
  ds_read_b64 v[214:215], v9 offset:1064
  s_waitcnt vmcnt(4) lgkmcnt(4)
  v_mfma_f32_16x16x32_bf16 v[64:67], v[56:59], v[36:39], 0
  v_mfma_f32_16x16x32_bf16 v[68:71], v[56:59], v[40:43], 0
  v_and_or_b32 v219, v217, v35, v2
  v_mul_f32 v220, v216, v3
  v_and_b32 v221, 14, v217
  buffer_load_dwordx4 v[56:59], v219, s[4:7], 0 idxen
  v_cos_f32 v220, v220
  v_lshl_add_u32 v248, v221, 3, v4
  v_cvt_pk_bf16_f32 v243, v220, v220
  s_cmp_lg_u32 s40, 0
  s_cbranch_scc1 L_x2
L_x2_back:
  v_cvt_pk_bf16_f32 v72, v64, v65
  v_cvt_pk_bf16_f32 v73, v66, v67
  v_cvt_pk_bf16_f32 v74, v68, v69
  v_cvt_pk_bf16_f32 v75, v70, v71
  s_waitcnt lgkmcnt(2)
  s_nop 0
  v_mfma_f32_16x16x32_bf16 v[172:175], v[72:75], v[76:79], v[172:175]
  ds_write_b16 v249, v244
  ds_read_b128 v[76:79], v5
  ds_write_b16 v249, v18
  ds_read_b64 v[216:217], v9 offset:1328
  s_waitcnt vmcnt(4) lgkmcnt(4)
  v_mfma_f32_16x16x32_bf16 v[64:67], v[60:63], v[36:39], 0
  v_mfma_f32_16x16x32_bf16 v[68:71], v[60:63], v[40:43], 0
  v_and_or_b32 v219, v215, v35, v2
  v_mul_f32 v220, v214, v3
  v_and_b32 v221, 14, v215
  buffer_load_dwordx4 v[60:63], v219, s[4:7], 0 idxen
  v_cos_f32 v220, v220
  v_lshl_add_u32 v249, v221, 3, v4
  v_cvt_pk_bf16_f32 v244, v220, v220
  v_mov_b32 v226, 0
  v_mov_b32 v227, v232
  v_mov_b32 v228, 0
  v_mov_b32 v229, v234
  v_mov_b32 v230, 0
  v_mov_b32 v231, v236
  v_cvt_pk_bf16_f32 v72, v64, v65
  v_cvt_pk_bf16_f32 v73, v66, v67
  v_cvt_pk_bf16_f32 v74, v68, v69
  v_cvt_pk_bf16_f32 v75, v70, v71
  s_waitcnt lgkmcnt(2)
  s_nop 0
  v_mfma_f32_16x16x32_bf16 v[176:179], v[72:75], v[76:79], v[176:179]
  ds_write_b16 v245, v240
  ds_read_b128 v[76:79], v5
  ds_write_b16 v245, v18
  ds_read_b64 v[214:215], v9 offset:1592
  s_waitcnt vmcnt(4) lgkmcnt(4)
  v_mfma_f32_16x16x32_bf16 v[64:67], v[44:47], v[36:39], 0
  v_mfma_f32_16x16x32_bf16 v[68:71], v[44:47], v[40:43], 0
  v_and_or_b32 v219, v217, v35, v2
  v_mul_f32 v220, v216, v3
  v_and_b32 v221, 14, v217
  buffer_load_dwordx4 v[44:47], v219, s[4:7], 0 idxen
  v_cos_f32 v220, v220
  v_lshl_add_u32 v245, v221, 3, v4
  v_cvt_pk_bf16_f32 v240, v220, v220
  v_mfma_f32_16x16x16_bf16 v[180:183], v[232:233], v[20:21], 0
  v_mfma_f32_16x16x16_bf16 v[184:187], v[234:235], v[20:21], 0
  v_cvt_pk_bf16_f32 v72, v64, v65
  v_cvt_pk_bf16_f32 v73, v66, v67
  v_cvt_pk_bf16_f32 v74, v68, v69
  v_cvt_pk_bf16_f32 v75, v70, v71
  s_waitcnt lgkmcnt(2)
  s_nop 0
  v_mfma_f32_16x16x32_bf16 v[80:83], v[72:75], v[76:79], v[80:83]
  s_cmp_lg_u32 s40, 0
  s_cbranch_scc1 L_x3
L_x3_back:
  ds_write_b16 v246, v241
  ds_read_b128 v[76:79], v5
  ds_write_b16 v246, v18
  ds_read_b64 v[216:217], v9 offset:1856
  s_waitcnt vmcnt(4) lgkmcnt(4)
  v_mfma_f32_16x16x32_bf16 v[64:67], v[48:51], v[36:39], 0
  v_mfma_f32_16x16x32_bf16 v[68:71], v[48:51], v[40:43], 0
  v_and_or_b32 v219, v215, v35, v2
  v_mul_f32 v220, v214, v3
  v_and_b32 v221, 14, v215
  buffer_load_dwordx4 v[48:51], v219, s[4:7], 0 idxen
  v_cos_f32 v220, v220
  v_lshl_add_u32 v246, v221, 3, v4
  v_cvt_pk_bf16_f32 v241, v220, v220
  v_cvt_pk_bf16_f32 v72, v64, v65
  v_cvt_pk_bf16_f32 v73, v66, v67
  v_cvt_pk_bf16_f32 v74, v68, v69
  v_cvt_pk_bf16_f32 v75, v70, v71
  s_waitcnt lgkmcnt(2)
  s_nop 0
  v_mfma_f32_16x16x32_bf16 v[84:87], v[72:75], v[76:79], v[84:87]
  ds_write_b16 v247, v242
  ds_read_b128 v[76:79], v5
  ds_write_b16 v247, v18
  ds_read_b64 v[214:215], v9 offset:2120
  s_waitcnt vmcnt(4) lgkmcnt(4)
  v_mfma_f32_16x16x32_bf16 v[64:67], v[52:55], v[36:39], 0
  v_mfma_f32_16x16x32_bf16 v[68:71], v[52:55], v[40:43], 0
  v_and_or_b32 v219, v217, v35, v2
  v_mul_f32 v220, v216, v3
  v_and_b32 v221, 14, v217
  buffer_load_dwordx4 v[52:55], v219, s[4:7], 0 idxen
  v_cos_f32 v220, v220
  v_lshl_add_u32 v247, v221, 3, v4
  v_cvt_pk_bf16_f32 v242, v220, v220
  v_mul_f32 v222, v80, v180
  v_mul_f32 v223, v81, v181
  v_mul_f32 v224, v82, v182
  v_mul_f32 v225, v83, v183
  v_mul_f32_dpp v222, v84, v180 row_ror:8 row_mask:0xf bank_mask:0xc
  v_mul_f32_dpp v223, v85, v181 row_ror:8 row_mask:0xf bank_mask:0xc
  v_mul_f32_dpp v224, v86, v182 row_ror:8 row_mask:0xf bank_mask:0xc
  v_mul_f32_dpp v225, v87, v183 row_ror:8 row_mask:0xf bank_mask:0xc
  v_fmac_f32_dpp v222, v80, v184 row_ror:8 row_mask:0xf bank_mask:0x3
  v_fmac_f32_dpp v223, v81, v185 row_ror:8 row_mask:0xf bank_mask:0x3
  v_fmac_f32_dpp v224, v82, v186 row_ror:8 row_mask:0xf bank_mask:0x3
  v_fmac_f32_dpp v225, v83, v187 row_ror:8 row_mask:0xf bank_mask:0x3
  v_fmac_f32_dpp v222, v84, v184 quad_perm:[0,1,2,3] row_mask:0xf bank_mask:0xc
  v_fmac_f32_dpp v223, v85, v185 quad_perm:[0,1,2,3] row_mask:0xf bank_mask:0xc
  v_fmac_f32_dpp v224, v86, v186 quad_perm:[0,1,2,3] row_mask:0xf bank_mask:0xc
  v_fmac_f32_dpp v225, v87, v187 quad_perm:[0,1,2,3] row_mask:0xf bank_mask:0xc
  v_cvt_pk_bf16_f32 v250, v222, v223
  v_cvt_pk_bf16_f32 v251, v224, v225
  v_mfma_f32_16x16x16_bf16 v[188:191], v[236:237], v[20:21], 0
  v_mfma_f32_16x16x16_bf16 v[180:183], v[226:227], v[20:21], 0
  v_mfma_f32_16x16x16_bf16 v[184:187], v[228:229], v[20:21], 0
  v_mfma_f32_16x16x16_bf16 v[222:225], v[238:239], v[250:251], 0
  v_cvt_pk_bf16_f32 v72, v64, v65
  v_cvt_pk_bf16_f32 v73, v66, v67
  v_cvt_pk_bf16_f32 v74, v68, v69
  v_cvt_pk_bf16_f32 v75, v70, v71
  s_waitcnt lgkmcnt(2)
  s_nop 0
  v_mfma_f32_16x16x32_bf16 v[88:91], v[72:75], v[76:79], v[88:91]
  ds_write_b16 v248, v243
  ds_read_b128 v[76:79], v5
  ds_write_b16 v248, v18
  ds_read_b64 v[216:217], v9 offset:2384
  s_waitcnt vmcnt(4) lgkmcnt(4)
  v_mfma_f32_16x16x32_bf16 v[64:67], v[56:59], v[36:39], 0
  v_mfma_f32_16x16x32_bf16 v[68:71], v[56:59], v[40:43], 0
  v_and_or_b32 v219, v215, v35, v2
  v_mul_f32 v220, v214, v3
  v_and_b32 v221, 14, v215
  buffer_load_dwordx4 v[56:59], v219, s[4:7], 0 idxen
  v_cos_f32 v220, v220
  v_lshl_add_u32 v248, v221, 3, v4
  v_cvt_pk_bf16_f32 v243, v220, v220
  v_lshlrev_b32 v80, 16, v192
  v_and_b32 v81, 0xffff0000, v192
  v_lshlrev_b32 v82, 16, v193
  v_and_b32 v83, 0xffff0000, v193
  v_pk_fma_f32 v[80:81], v[222:223], v[188:189], v[80:81]
  v_pk_fma_f32 v[82:83], v[224:225], v[190:191], v[82:83]
  v_cvt_pk_bf16_f32 v80, v80, v81
  v_cvt_pk_bf16_f32 v81, v82, v83
  ds_write_b64 v7, v[80:81] offset:0
  v_cvt_pk_bf16_f32 v72, v64, v65
  v_cvt_pk_bf16_f32 v73, v66, v67
  v_cvt_pk_bf16_f32 v74, v68, v69
  v_cvt_pk_bf16_f32 v75, v70, v71
  s_waitcnt lgkmcnt(2)
  s_nop 0
  v_mfma_f32_16x16x32_bf16 v[92:95], v[72:75], v[76:79], v[92:95]
  ds_write_b16 v249, v244
  ds_read_b128 v[76:79], v5
  ds_write_b16 v249, v18
  ds_read_b64 v[214:215], v9 offset:2648
  s_waitcnt vmcnt(4) lgkmcnt(4)
  v_mfma_f32_16x16x32_bf16 v[64:67], v[60:63], v[36:39], 0
  v_mfma_f32_16x16x32_bf16 v[68:71], v[60:63], v[40:43], 0
  v_and_or_b32 v219, v217, v35, v2
  v_mul_f32 v220, v216, v3
  v_and_b32 v221, 14, v217
  buffer_load_dwordx4 v[60:63], v219, s[4:7], 0 idxen
  v_cos_f32 v220, v220
  v_lshl_add_u32 v249, v221, 3, v4
  v_cvt_pk_bf16_f32 v244, v220, v220
  v_mul_f32 v222, v88, v180
  v_mul_f32 v223, v89, v181
  v_mul_f32 v224, v90, v182
  v_mul_f32 v225, v91, v183
  v_mul_f32_dpp v222, v92, v180 row_ror:8 row_mask:0xf bank_mask:0xc
  v_mul_f32_dpp v223, v93, v181 row_ror:8 row_mask:0xf bank_mask:0xc
  v_mul_f32_dpp v224, v94, v182 row_ror:8 row_mask:0xf bank_mask:0xc
  v_mul_f32_dpp v225, v95, v183 row_ror:8 row_mask:0xf bank_mask:0xc
  v_fmac_f32_dpp v222, v88, v184 row_ror:8 row_mask:0xf bank_mask:0x3
  v_fmac_f32_dpp v223, v89, v185 row_ror:8 row_mask:0xf bank_mask:0x3
  v_fmac_f32_dpp v224, v90, v186 row_ror:8 row_mask:0xf bank_mask:0x3
  v_fmac_f32_dpp v225, v91, v187 row_ror:8 row_mask:0xf bank_mask:0x3
  v_fmac_f32_dpp v222, v92, v184 quad_perm:[0,1,2,3] row_mask:0xf bank_mask:0xc
  v_fmac_f32_dpp v223, v93, v185 quad_perm:[0,1,2,3] row_mask:0xf bank_mask:0xc
  v_fmac_f32_dpp v224, v94, v186 quad_perm:[0,1,2,3] row_mask:0xf bank_mask:0xc
  v_fmac_f32_dpp v225, v95, v187 quad_perm:[0,1,2,3] row_mask:0xf bank_mask:0xc
  v_cvt_pk_bf16_f32 v250, v222, v223
  v_cvt_pk_bf16_f32 v251, v224, v225
  v_mfma_f32_16x16x16_bf16 v[188:191], v[230:231], v[20:21], 0
  v_mfma_f32_16x16x16_bf16 v[180:183], v[232:233], v[22:23], 0
  v_mfma_f32_16x16x16_bf16 v[184:187], v[234:235], v[22:23], 0
  v_mfma_f32_16x16x16_bf16 v[222:225], v[238:239], v[250:251], 0
  v_cvt_pk_bf16_f32 v72, v64, v65
  v_cvt_pk_bf16_f32 v73, v66, v67
  v_cvt_pk_bf16_f32 v74, v68, v69
  v_cvt_pk_bf16_f32 v75, v70, v71
  s_waitcnt lgkmcnt(2)
  s_nop 0
  v_mfma_f32_16x16x32_bf16 v[96:99], v[72:75], v[76:79], v[96:99]
  ds_write_b16 v245, v240
  ds_read_b128 v[76:79], v5
  ds_write_b16 v245, v18
  ds_read_b64 v[216:217], v9 offset:2912
  s_waitcnt vmcnt(4) lgkmcnt(4)
  v_mfma_f32_16x16x32_bf16 v[64:67], v[44:47], v[36:39], 0
  v_mfma_f32_16x16x32_bf16 v[68:71], v[44:47], v[40:43], 0
  v_and_or_b32 v219, v215, v35, v2
  v_mul_f32 v220, v214, v3
  v_and_b32 v221, 14, v215
  buffer_load_dwordx4 v[44:47], v219, s[4:7], 0 idxen
  v_cos_f32 v220, v220
  v_lshl_add_u32 v245, v221, 3, v4
  v_cvt_pk_bf16_f32 v240, v220, v220
  v_lshlrev_b32 v88, 16, v194
  v_and_b32 v89, 0xffff0000, v194
  v_lshlrev_b32 v90, 16, v195
  v_and_b32 v91, 0xffff0000, v195
  v_pk_fma_f32 v[88:89], v[222:223], v[188:189], v[88:89]
  v_pk_fma_f32 v[90:91], v[224:225], v[190:191], v[90:91]
  v_cvt_pk_bf16_f32 v88, v88, v89
  v_cvt_pk_bf16_f32 v89, v90, v91
  ds_write_b64 v7, v[88:89] offset:512
  ds_read_b128 v[84:87], v8 offset:0
  v_cvt_pk_bf16_f32 v72, v64, v65
  v_cvt_pk_bf16_f32 v73, v66, v67
  v_cvt_pk_bf16_f32 v74, v68, v69
  v_cvt_pk_bf16_f32 v75, v70, v71
  s_waitcnt lgkmcnt(2)
  s_nop 0
  v_mfma_f32_16x16x32_bf16 v[100:103], v[72:75], v[76:79], v[100:103]
  ds_write_b16 v246, v241
  ds_read_b128 v[76:79], v5
  ds_write_b16 v246, v18
  ds_read_b64 v[214:215], v9 offset:3176
  s_waitcnt vmcnt(4) lgkmcnt(4)
  v_mfma_f32_16x16x32_bf16 v[64:67], v[48:51], v[36:39], 0
  v_mfma_f32_16x16x32_bf16 v[68:71], v[48:51], v[40:43], 0
  v_and_or_b32 v219, v217, v35, v2
  v_mul_f32 v220, v216, v3
  v_and_b32 v221, 14, v217
  buffer_load_dwordx4 v[48:51], v219, s[4:7], 0 idxen
  v_cos_f32 v220, v220
  v_lshl_add_u32 v246, v221, 3, v4
  v_cvt_pk_bf16_f32 v241, v220, v220
  buffer_store_dwordx4 v[84:87], v6, s[20:23], s43 offen offset:0 nt
  v_mul_f32 v222, v96, v180
  v_mul_f32 v223, v97, v181
  v_mul_f32 v224, v98, v182
  v_mul_f32 v225, v99, v183
  v_mul_f32_dpp v222, v100, v180 row_ror:8 row_mask:0xf bank_mask:0xc
  v_mul_f32_dpp v223, v101, v181 row_ror:8 row_mask:0xf bank_mask:0xc
  v_mul_f32_dpp v224, v102, v182 row_ror:8 row_mask:0xf bank_mask:0xc
  v_mul_f32_dpp v225, v103, v183 row_ror:8 row_mask:0xf bank_mask:0xc
  v_fmac_f32_dpp v222, v96, v184 row_ror:8 row_mask:0xf bank_mask:0x3
  v_fmac_f32_dpp v223, v97, v185 row_ror:8 row_mask:0xf bank_mask:0x3
  v_fmac_f32_dpp v224, v98, v186 row_ror:8 row_mask:0xf bank_mask:0x3
  v_fmac_f32_dpp v225, v99, v187 row_ror:8 row_mask:0xf bank_mask:0x3
  v_fmac_f32_dpp v222, v100, v184 quad_perm:[0,1,2,3] row_mask:0xf bank_mask:0xc
  v_fmac_f32_dpp v223, v101, v185 quad_perm:[0,1,2,3] row_mask:0xf bank_mask:0xc
  v_fmac_f32_dpp v224, v102, v186 quad_perm:[0,1,2,3] row_mask:0xf bank_mask:0xc
  v_fmac_f32_dpp v225, v103, v187 quad_perm:[0,1,2,3] row_mask:0xf bank_mask:0xc
  v_cvt_pk_bf16_f32 v250, v222, v223
  v_cvt_pk_bf16_f32 v251, v224, v225
  v_mfma_f32_16x16x16_bf16 v[188:191], v[236:237], v[22:23], 0
  v_mfma_f32_16x16x16_bf16 v[180:183], v[226:227], v[22:23], 0
  v_mfma_f32_16x16x16_bf16 v[184:187], v[228:229], v[22:23], 0
  v_mfma_f32_16x16x16_bf16 v[222:225], v[238:239], v[250:251], 0
  v_cvt_pk_bf16_f32 v72, v64, v65
  v_cvt_pk_bf16_f32 v73, v66, v67
  v_cvt_pk_bf16_f32 v74, v68, v69
  v_cvt_pk_bf16_f32 v75, v70, v71
  s_waitcnt lgkmcnt(2)
  s_nop 0
  v_mfma_f32_16x16x32_bf16 v[104:107], v[72:75], v[76:79], v[104:107]
  ds_write_b16 v247, v242
  ds_read_b128 v[76:79], v5
  ds_write_b16 v247, v18
  ds_read_b64 v[216:217], v9 offset:3440
  s_waitcnt vmcnt(5) lgkmcnt(4)
  v_mfma_f32_16x16x32_bf16 v[64:67], v[52:55], v[36:39], 0
  v_mfma_f32_16x16x32_bf16 v[68:71], v[52:55], v[40:43], 0
  v_and_or_b32 v219, v215, v35, v2
  v_mul_f32 v220, v214, v3
  v_and_b32 v221, 14, v215
  buffer_load_dwordx4 v[52:55], v219, s[4:7], 0 idxen
  v_cos_f32 v220, v220
  v_lshl_add_u32 v247, v221, 3, v4
  v_cvt_pk_bf16_f32 v242, v220, v220
  v_lshlrev_b32 v96, 16, v196
  v_and_b32 v97, 0xffff0000, v196
  v_lshlrev_b32 v98, 16, v197
  v_and_b32 v99, 0xffff0000, v197
  v_pk_fma_f32 v[96:97], v[222:223], v[188:189], v[96:97]
  v_pk_fma_f32 v[98:99], v[224:225], v[190:191], v[98:99]
  v_cvt_pk_bf16_f32 v96, v96, v97
  v_cvt_pk_bf16_f32 v97, v98, v99
  ds_write_b64 v7, v[96:97] offset:1024
  v_cvt_pk_bf16_f32 v72, v64, v65
  v_cvt_pk_bf16_f32 v73, v66, v67
  v_cvt_pk_bf16_f32 v74, v68, v69
  v_cvt_pk_bf16_f32 v75, v70, v71
  s_waitcnt lgkmcnt(2)
  s_nop 0
  v_mfma_f32_16x16x32_bf16 v[108:111], v[72:75], v[76:79], v[108:111]
  ds_write_b16 v248, v243
  ds_read_b128 v[76:79], v5
  ds_write_b16 v248, v18
  ds_read_b64 v[214:215], v9 offset:3704
  s_waitcnt vmcnt(5) lgkmcnt(4)
  v_mfma_f32_16x16x32_bf16 v[64:67], v[56:59], v[36:39], 0
  v_mfma_f32_16x16x32_bf16 v[68:71], v[56:59], v[40:43], 0
  v_and_or_b32 v219, v217, v35, v2
  v_mul_f32 v220, v216, v3
  v_and_b32 v221, 14, v217
  buffer_load_dwordx4 v[56:59], v219, s[4:7], 0 idxen
  v_cos_f32 v220, v220
  v_lshl_add_u32 v248, v221, 3, v4
  v_cvt_pk_bf16_f32 v243, v220, v220
  v_mul_f32 v222, v104, v180
  v_mul_f32 v223, v105, v181
  v_mul_f32 v224, v106, v182
  v_mul_f32 v225, v107, v183
  v_mul_f32_dpp v222, v108, v180 row_ror:8 row_mask:0xf bank_mask:0xc
  v_mul_f32_dpp v223, v109, v181 row_ror:8 row_mask:0xf bank_mask:0xc
  v_mul_f32_dpp v224, v110, v182 row_ror:8 row_mask:0xf bank_mask:0xc
  v_mul_f32_dpp v225, v111, v183 row_ror:8 row_mask:0xf bank_mask:0xc
  v_fmac_f32_dpp v222, v104, v184 row_ror:8 row_mask:0xf bank_mask:0x3
  v_fmac_f32_dpp v223, v105, v185 row_ror:8 row_mask:0xf bank_mask:0x3
  v_fmac_f32_dpp v224, v106, v186 row_ror:8 row_mask:0xf bank_mask:0x3
  v_fmac_f32_dpp v225, v107, v187 row_ror:8 row_mask:0xf bank_mask:0x3
  v_fmac_f32_dpp v222, v108, v184 quad_perm:[0,1,2,3] row_mask:0xf bank_mask:0xc
  v_fmac_f32_dpp v223, v109, v185 quad_perm:[0,1,2,3] row_mask:0xf bank_mask:0xc
  v_fmac_f32_dpp v224, v110, v186 quad_perm:[0,1,2,3] row_mask:0xf bank_mask:0xc
  v_fmac_f32_dpp v225, v111, v187 quad_perm:[0,1,2,3] row_mask:0xf bank_mask:0xc
  v_cvt_pk_bf16_f32 v250, v222, v223
  v_cvt_pk_bf16_f32 v251, v224, v225
  v_mfma_f32_16x16x16_bf16 v[188:191], v[230:231], v[22:23], 0
  v_mfma_f32_16x16x16_bf16 v[180:183], v[232:233], v[24:25], 0
  v_mfma_f32_16x16x16_bf16 v[184:187], v[234:235], v[24:25], 0
  v_mfma_f32_16x16x16_bf16 v[222:225], v[238:239], v[250:251], 0
  v_cvt_pk_bf16_f32 v72, v64, v65
  v_cvt_pk_bf16_f32 v73, v66, v67
  v_cvt_pk_bf16_f32 v74, v68, v69
  v_cvt_pk_bf16_f32 v75, v70, v71
  s_waitcnt lgkmcnt(2)
  s_nop 0
  v_mfma_f32_16x16x32_bf16 v[112:115], v[72:75], v[76:79], v[112:115]
  ds_write_b16 v249, v244
  ds_read_b128 v[76:79], v5
  ds_write_b16 v249, v18
  ds_read_b64 v[216:217], v9 offset:3968
  s_waitcnt vmcnt(5) lgkmcnt(4)
  v_mfma_f32_16x16x32_bf16 v[64:67], v[60:63], v[36:39], 0
  v_mfma_f32_16x16x32_bf16 v[68:71], v[60:63], v[40:43], 0
  v_and_or_b32 v219, v215, v35, v2
  v_mul_f32 v220, v214, v3
  v_and_b32 v221, 14, v215
  buffer_load_dwordx4 v[60:63], v219, s[4:7], 0 idxen
  v_cos_f32 v220, v220
  v_lshl_add_u32 v249, v221, 3, v4
  v_cvt_pk_bf16_f32 v244, v220, v220
  v_lshlrev_b32 v104, 16, v198
  v_and_b32 v105, 0xffff0000, v198
  v_lshlrev_b32 v106, 16, v199
  v_and_b32 v107, 0xffff0000, v199
  v_pk_fma_f32 v[104:105], v[222:223], v[188:189], v[104:105]
  v_pk_fma_f32 v[106:107], v[224:225], v[190:191], v[106:107]
  v_cvt_pk_bf16_f32 v104, v104, v105
  v_cvt_pk_bf16_f32 v105, v106, v107
  ds_write_b64 v7, v[104:105] offset:1536
  ds_read_b128 v[100:103], v8 offset:1024
  v_cvt_pk_bf16_f32 v72, v64, v65
  v_cvt_pk_bf16_f32 v73, v66, v67
  v_cvt_pk_bf16_f32 v74, v68, v69
  v_cvt_pk_bf16_f32 v75, v70, v71
  s_waitcnt lgkmcnt(2)
  s_nop 0
  v_mfma_f32_16x16x32_bf16 v[116:119], v[72:75], v[76:79], v[116:119]
  ds_write_b16 v245, v240
  ds_read_b128 v[76:79], v5
  ds_write_b16 v245, v18
  ds_read_b64 v[214:215], v9 offset:4232
  s_waitcnt vmcnt(5) lgkmcnt(4)
  v_mfma_f32_16x16x32_bf16 v[64:67], v[44:47], v[36:39], 0
  v_mfma_f32_16x16x32_bf16 v[68:71], v[44:47], v[40:43], 0
  v_and_or_b32 v219, v217, v35, v2
  v_mul_f32 v220, v216, v3
  v_and_b32 v221, 14, v217
  buffer_load_dwordx4 v[44:47], v219, s[4:7], 0 idxen
  v_cos_f32 v220, v220
  v_lshl_add_u32 v245, v221, 3, v4
  v_cvt_pk_bf16_f32 v240, v220, v220
  buffer_store_dwordx4 v[100:103], v6, s[20:23], s43 offen offset:1024 nt
  v_mul_f32 v222, v112, v180
  v_mul_f32 v223, v113, v181
  v_mul_f32 v224, v114, v182
  v_mul_f32 v225, v115, v183
  v_mul_f32_dpp v222, v116, v180 row_ror:8 row_mask:0xf bank_mask:0xc
  v_mul_f32_dpp v223, v117, v181 row_ror:8 row_mask:0xf bank_mask:0xc
  v_mul_f32_dpp v224, v118, v182 row_ror:8 row_mask:0xf bank_mask:0xc
  v_mul_f32_dpp v225, v119, v183 row_ror:8 row_mask:0xf bank_mask:0xc
  v_fmac_f32_dpp v222, v112, v184 row_ror:8 row_mask:0xf bank_mask:0x3
  v_fmac_f32_dpp v223, v113, v185 row_ror:8 row_mask:0xf bank_mask:0x3
  v_fmac_f32_dpp v224, v114, v186 row_ror:8 row_mask:0xf bank_mask:0x3
  v_fmac_f32_dpp v225, v115, v187 row_ror:8 row_mask:0xf bank_mask:0x3
  v_fmac_f32_dpp v222, v116, v184 quad_perm:[0,1,2,3] row_mask:0xf bank_mask:0xc
  v_fmac_f32_dpp v223, v117, v185 quad_perm:[0,1,2,3] row_mask:0xf bank_mask:0xc
  v_fmac_f32_dpp v224, v118, v186 quad_perm:[0,1,2,3] row_mask:0xf bank_mask:0xc
  v_fmac_f32_dpp v225, v119, v187 quad_perm:[0,1,2,3] row_mask:0xf bank_mask:0xc
  v_cvt_pk_bf16_f32 v250, v222, v223
  v_cvt_pk_bf16_f32 v251, v224, v225
  v_mfma_f32_16x16x16_bf16 v[188:191], v[236:237], v[24:25], 0
  v_mfma_f32_16x16x16_bf16 v[180:183], v[226:227], v[24:25], 0
  v_mfma_f32_16x16x16_bf16 v[184:187], v[228:229], v[24:25], 0
  v_mfma_f32_16x16x16_bf16 v[222:225], v[238:239], v[250:251], 0
  v_cvt_pk_bf16_f32 v72, v64, v65
  v_cvt_pk_bf16_f32 v73, v66, v67
  v_cvt_pk_bf16_f32 v74, v68, v69
  v_cvt_pk_bf16_f32 v75, v70, v71
  s_waitcnt lgkmcnt(2)
  s_nop 0
  v_mfma_f32_16x16x32_bf16 v[120:123], v[72:75], v[76:79], v[120:123]
  ds_write_b16 v246, v241
  ds_read_b128 v[76:79], v5
  ds_write_b16 v246, v18
  ds_read_b64 v[216:217], v9 offset:4496
  s_waitcnt vmcnt(6) lgkmcnt(4)
  v_mfma_f32_16x16x32_bf16 v[64:67], v[48:51], v[36:39], 0
  v_mfma_f32_16x16x32_bf16 v[68:71], v[48:51], v[40:43], 0
  v_and_or_b32 v219, v215, v35, v2
  v_mul_f32 v220, v214, v3
  v_and_b32 v221, 14, v215
  buffer_load_dwordx4 v[48:51], v219, s[4:7], 0 idxen
  v_cos_f32 v220, v220
  v_lshl_add_u32 v246, v221, 3, v4
  v_cvt_pk_bf16_f32 v241, v220, v220
  v_lshlrev_b32 v112, 16, v200
  v_and_b32 v113, 0xffff0000, v200
  v_lshlrev_b32 v114, 16, v201
  v_and_b32 v115, 0xffff0000, v201
  v_pk_fma_f32 v[112:113], v[222:223], v[188:189], v[112:113]
  v_pk_fma_f32 v[114:115], v[224:225], v[190:191], v[114:115]
  v_cvt_pk_bf16_f32 v112, v112, v113
  v_cvt_pk_bf16_f32 v113, v114, v115
  ds_write_b64 v7, v[112:113] offset:2048
  v_cvt_pk_bf16_f32 v72, v64, v65
  v_cvt_pk_bf16_f32 v73, v66, v67
  v_cvt_pk_bf16_f32 v74, v68, v69
  v_cvt_pk_bf16_f32 v75, v70, v71
  s_waitcnt lgkmcnt(2)
  s_nop 0
  v_mfma_f32_16x16x32_bf16 v[124:127], v[72:75], v[76:79], v[124:127]
  ds_write_b16 v247, v242
  ds_read_b128 v[76:79], v5
  ds_write_b16 v247, v18
  ds_read_b64 v[214:215], v9 offset:4760
  s_waitcnt vmcnt(5) lgkmcnt(4)
  v_mfma_f32_16x16x32_bf16 v[64:67], v[52:55], v[36:39], 0
  v_mfma_f32_16x16x32_bf16 v[68:71], v[52:55], v[40:43], 0
  v_and_or_b32 v219, v217, v35, v2
  v_mul_f32 v220, v216, v3
  v_and_b32 v221, 14, v217
  buffer_load_dwordx4 v[52:55], v219, s[4:7], 0 idxen
  v_cos_f32 v220, v220
  v_lshl_add_u32 v247, v221, 3, v4
  v_cvt_pk_bf16_f32 v242, v220, v220
  v_mul_f32 v222, v120, v180
  v_mul_f32 v223, v121, v181
  v_mul_f32 v224, v122, v182
  v_mul_f32 v225, v123, v183
  v_mul_f32_dpp v222, v124, v180 row_ror:8 row_mask:0xf bank_mask:0xc
  v_mul_f32_dpp v223, v125, v181 row_ror:8 row_mask:0xf bank_mask:0xc
  v_mul_f32_dpp v224, v126, v182 row_ror:8 row_mask:0xf bank_mask:0xc
  v_mul_f32_dpp v225, v127, v183 row_ror:8 row_mask:0xf bank_mask:0xc
  v_fmac_f32_dpp v222, v120, v184 row_ror:8 row_mask:0xf bank_mask:0x3
  v_fmac_f32_dpp v223, v121, v185 row_ror:8 row_mask:0xf bank_mask:0x3
  v_fmac_f32_dpp v224, v122, v186 row_ror:8 row_mask:0xf bank_mask:0x3
  v_fmac_f32_dpp v225, v123, v187 row_ror:8 row_mask:0xf bank_mask:0x3
  v_fmac_f32_dpp v222, v124, v184 quad_perm:[0,1,2,3] row_mask:0xf bank_mask:0xc
  v_fmac_f32_dpp v223, v125, v185 quad_perm:[0,1,2,3] row_mask:0xf bank_mask:0xc
  v_fmac_f32_dpp v224, v126, v186 quad_perm:[0,1,2,3] row_mask:0xf bank_mask:0xc
  v_fmac_f32_dpp v225, v127, v187 quad_perm:[0,1,2,3] row_mask:0xf bank_mask:0xc
  v_cvt_pk_bf16_f32 v250, v222, v223
  v_cvt_pk_bf16_f32 v251, v224, v225
  v_mfma_f32_16x16x16_bf16 v[188:191], v[230:231], v[24:25], 0
  v_mfma_f32_16x16x16_bf16 v[180:183], v[232:233], v[26:27], 0
  v_mfma_f32_16x16x16_bf16 v[184:187], v[234:235], v[26:27], 0
  v_mfma_f32_16x16x16_bf16 v[222:225], v[238:239], v[250:251], 0
  v_cvt_pk_bf16_f32 v72, v64, v65
  v_cvt_pk_bf16_f32 v73, v66, v67
  v_cvt_pk_bf16_f32 v74, v68, v69
  v_cvt_pk_bf16_f32 v75, v70, v71
  s_waitcnt lgkmcnt(2)
  s_nop 0
  v_mfma_f32_16x16x32_bf16 v[128:131], v[72:75], v[76:79], v[128:131]
  ds_write_b16 v248, v243
  ds_read_b128 v[76:79], v5
  ds_write_b16 v248, v18
  ds_read_b64 v[216:217], v9 offset:5024
  s_waitcnt vmcnt(5) lgkmcnt(4)
  v_mfma_f32_16x16x32_bf16 v[64:67], v[56:59], v[36:39], 0
  v_mfma_f32_16x16x32_bf16 v[68:71], v[56:59], v[40:43], 0
  v_and_or_b32 v219, v215, v35, v2
  v_mul_f32 v220, v214, v3
  v_and_b32 v221, 14, v215
  buffer_load_dwordx4 v[56:59], v219, s[4:7], 0 idxen
  v_cos_f32 v220, v220
  v_lshl_add_u32 v248, v221, 3, v4
  v_cvt_pk_bf16_f32 v243, v220, v220
  s_setprio 0
  v_lshlrev_b32 v120, 16, v202
  v_and_b32 v121, 0xffff0000, v202
  v_lshlrev_b32 v122, 16, v203
  v_and_b32 v123, 0xffff0000, v203
  v_pk_fma_f32 v[120:121], v[222:223], v[188:189], v[120:121]
  v_pk_fma_f32 v[122:123], v[224:225], v[190:191], v[122:123]
  v_cvt_pk_bf16_f32 v120, v120, v121
  v_cvt_pk_bf16_f32 v121, v122, v123
  ds_write_b64 v7, v[120:121] offset:2560
  ds_read_b128 v[116:119], v8 offset:2048
  v_cvt_pk_bf16_f32 v72, v64, v65
  v_cvt_pk_bf16_f32 v73, v66, v67
  v_cvt_pk_bf16_f32 v74, v68, v69
  v_cvt_pk_bf16_f32 v75, v70, v71
  s_waitcnt lgkmcnt(2)
  s_nop 0
  v_mfma_f32_16x16x32_bf16 v[132:135], v[72:75], v[76:79], v[132:135]
  ds_write_b16 v249, v244
  ds_read_b128 v[76:79], v5
  ds_write_b16 v249, v18
  ds_read_b64 v[214:215], v9 offset:5288
  s_waitcnt vmcnt(5) lgkmcnt(4)
  v_mfma_f32_16x16x32_bf16 v[64:67], v[60:63], v[36:39], 0
  v_mfma_f32_16x16x32_bf16 v[68:71], v[60:63], v[40:43], 0
  v_and_or_b32 v219, v217, v35, v2
  v_mul_f32 v220, v216, v3
  v_and_b32 v221, 14, v217
  buffer_load_dwordx4 v[60:63], v219, s[4:7], 0 idxen
  v_cos_f32 v220, v220
  v_lshl_add_u32 v249, v221, 3, v4
  v_cvt_pk_bf16_f32 v244, v220, v220
  buffer_store_dwordx4 v[116:119], v6, s[20:23], s43 offen offset:2048 nt
  v_mul_f32 v222, v128, v180
  v_mul_f32 v223, v129, v181
  v_mul_f32 v224, v130, v182
  v_mul_f32 v225, v131, v183
  v_mul_f32_dpp v222, v132, v180 row_ror:8 row_mask:0xf bank_mask:0xc
  v_mul_f32_dpp v223, v133, v181 row_ror:8 row_mask:0xf bank_mask:0xc
  v_mul_f32_dpp v224, v134, v182 row_ror:8 row_mask:0xf bank_mask:0xc
  v_mul_f32_dpp v225, v135, v183 row_ror:8 row_mask:0xf bank_mask:0xc
  v_fmac_f32_dpp v222, v128, v184 row_ror:8 row_mask:0xf bank_mask:0x3
  v_fmac_f32_dpp v223, v129, v185 row_ror:8 row_mask:0xf bank_mask:0x3
  v_fmac_f32_dpp v224, v130, v186 row_ror:8 row_mask:0xf bank_mask:0x3
  v_fmac_f32_dpp v225, v131, v187 row_ror:8 row_mask:0xf bank_mask:0x3
  v_fmac_f32_dpp v222, v132, v184 quad_perm:[0,1,2,3] row_mask:0xf bank_mask:0xc
  v_fmac_f32_dpp v223, v133, v185 quad_perm:[0,1,2,3] row_mask:0xf bank_mask:0xc
  v_fmac_f32_dpp v224, v134, v186 quad_perm:[0,1,2,3] row_mask:0xf bank_mask:0xc
  v_fmac_f32_dpp v225, v135, v187 quad_perm:[0,1,2,3] row_mask:0xf bank_mask:0xc
  v_cvt_pk_bf16_f32 v250, v222, v223
  v_cvt_pk_bf16_f32 v251, v224, v225
  v_mfma_f32_16x16x16_bf16 v[188:191], v[236:237], v[26:27], 0
  v_mfma_f32_16x16x16_bf16 v[180:183], v[226:227], v[26:27], 0
  v_mfma_f32_16x16x16_bf16 v[184:187], v[228:229], v[26:27], 0
  v_mfma_f32_16x16x16_bf16 v[222:225], v[238:239], v[250:251], 0
  v_cvt_pk_bf16_f32 v72, v64, v65
  v_cvt_pk_bf16_f32 v73, v66, v67
  v_cvt_pk_bf16_f32 v74, v68, v69
  v_cvt_pk_bf16_f32 v75, v70, v71
  s_waitcnt lgkmcnt(2)
  s_nop 0
  v_mfma_f32_16x16x32_bf16 v[136:139], v[72:75], v[76:79], v[136:139]
  ds_write_b16 v245, v240
  ds_read_b128 v[76:79], v5
  ds_write_b16 v245, v18
  ds_read_b64 v[216:217], v9 offset:5552
  s_waitcnt vmcnt(6) lgkmcnt(4)
  v_mfma_f32_16x16x32_bf16 v[64:67], v[44:47], v[36:39], 0
  v_mfma_f32_16x16x32_bf16 v[68:71], v[44:47], v[40:43], 0
  v_and_or_b32 v219, v215, v35, v2
  v_mul_f32 v220, v214, v3
  v_and_b32 v221, 14, v215
  buffer_load_dwordx4 v[44:47], v219, s[4:7], 0 idxen
  v_cos_f32 v220, v220
  v_lshl_add_u32 v245, v221, 3, v4
  v_cvt_pk_bf16_f32 v240, v220, v220
  v_lshlrev_b32 v128, 16, v204
  v_and_b32 v129, 0xffff0000, v204
  v_lshlrev_b32 v130, 16, v205
  v_and_b32 v131, 0xffff0000, v205
  v_pk_fma_f32 v[128:129], v[222:223], v[188:189], v[128:129]
  v_pk_fma_f32 v[130:131], v[224:225], v[190:191], v[130:131]
  v_cvt_pk_bf16_f32 v128, v128, v129
  v_cvt_pk_bf16_f32 v129, v130, v131
  ds_write_b64 v7, v[128:129] offset:3072
  v_cvt_pk_bf16_f32 v72, v64, v65
  v_cvt_pk_bf16_f32 v73, v66, v67
  v_cvt_pk_bf16_f32 v74, v68, v69
  v_cvt_pk_bf16_f32 v75, v70, v71
  s_waitcnt lgkmcnt(2)
  s_nop 0
  v_mfma_f32_16x16x32_bf16 v[140:143], v[72:75], v[76:79], v[140:143]
  ds_write_b16 v246, v241
  ds_read_b128 v[76:79], v5
  ds_write_b16 v246, v18
  ds_read_b64 v[214:215], v9 offset:5816
  s_waitcnt vmcnt(5) lgkmcnt(4)
  v_mfma_f32_16x16x32_bf16 v[64:67], v[48:51], v[36:39], 0
  v_mfma_f32_16x16x32_bf16 v[68:71], v[48:51], v[40:43], 0
  v_and_or_b32 v219, v217, v35, v2
  v_mul_f32 v220, v216, v3
  v_and_b32 v221, 14, v217
  buffer_load_dwordx4 v[48:51], v219, s[4:7], 0 idxen
  v_cos_f32 v220, v220
  v_lshl_add_u32 v246, v221, 3, v4
  v_cvt_pk_bf16_f32 v241, v220, v220
  v_mul_f32 v222, v136, v180
  v_mul_f32 v223, v137, v181
  v_mul_f32 v224, v138, v182
  v_mul_f32 v225, v139, v183
  v_mul_f32_dpp v222, v140, v180 row_ror:8 row_mask:0xf bank_mask:0xc
  v_mul_f32_dpp v223, v141, v181 row_ror:8 row_mask:0xf bank_mask:0xc
  v_mul_f32_dpp v224, v142, v182 row_ror:8 row_mask:0xf bank_mask:0xc
  v_mul_f32_dpp v225, v143, v183 row_ror:8 row_mask:0xf bank_mask:0xc
  v_fmac_f32_dpp v222, v136, v184 row_ror:8 row_mask:0xf bank_mask:0x3
  v_fmac_f32_dpp v223, v137, v185 row_ror:8 row_mask:0xf bank_mask:0x3
  v_fmac_f32_dpp v224, v138, v186 row_ror:8 row_mask:0xf bank_mask:0x3
  v_fmac_f32_dpp v225, v139, v187 row_ror:8 row_mask:0xf bank_mask:0x3
  v_fmac_f32_dpp v222, v140, v184 quad_perm:[0,1,2,3] row_mask:0xf bank_mask:0xc
  v_fmac_f32_dpp v223, v141, v185 quad_perm:[0,1,2,3] row_mask:0xf bank_mask:0xc
  v_fmac_f32_dpp v224, v142, v186 quad_perm:[0,1,2,3] row_mask:0xf bank_mask:0xc
  v_fmac_f32_dpp v225, v143, v187 quad_perm:[0,1,2,3] row_mask:0xf bank_mask:0xc
  v_cvt_pk_bf16_f32 v250, v222, v223
  v_cvt_pk_bf16_f32 v251, v224, v225
  v_mfma_f32_16x16x16_bf16 v[188:191], v[230:231], v[26:27], 0
  v_mfma_f32_16x16x16_bf16 v[180:183], v[232:233], v[28:29], 0
  v_mfma_f32_16x16x16_bf16 v[184:187], v[234:235], v[28:29], 0
  v_mfma_f32_16x16x16_bf16 v[222:225], v[238:239], v[250:251], 0
  v_cvt_pk_bf16_f32 v72, v64, v65
  v_cvt_pk_bf16_f32 v73, v66, v67
  v_cvt_pk_bf16_f32 v74, v68, v69
  v_cvt_pk_bf16_f32 v75, v70, v71
  s_waitcnt lgkmcnt(2)
  s_nop 0
  v_mfma_f32_16x16x32_bf16 v[144:147], v[72:75], v[76:79], v[144:147]
  ds_write_b16 v247, v242
  ds_read_b128 v[76:79], v5
  ds_write_b16 v247, v18
  ds_read_b64 v[216:217], v9 offset:6080
  s_waitcnt vmcnt(5) lgkmcnt(4)
  v_mfma_f32_16x16x32_bf16 v[64:67], v[52:55], v[36:39], 0
  v_mfma_f32_16x16x32_bf16 v[68:71], v[52:55], v[40:43], 0
  v_and_or_b32 v219, v215, v35, v2
  v_mul_f32 v220, v214, v3
  v_and_b32 v221, 14, v215
  buffer_load_dwordx4 v[52:55], v219, s[4:7], 0 idxen
  v_cos_f32 v220, v220
  v_lshl_add_u32 v247, v221, 3, v4
  v_cvt_pk_bf16_f32 v242, v220, v220
  v_lshlrev_b32 v136, 16, v206
  v_and_b32 v137, 0xffff0000, v206
  v_lshlrev_b32 v138, 16, v207
  v_and_b32 v139, 0xffff0000, v207
  v_pk_fma_f32 v[136:137], v[222:223], v[188:189], v[136:137]
  v_pk_fma_f32 v[138:139], v[224:225], v[190:191], v[138:139]
  v_cvt_pk_bf16_f32 v136, v136, v137
  v_cvt_pk_bf16_f32 v137, v138, v139
  ds_write_b64 v7, v[136:137] offset:3584
  ds_read_b128 v[132:135], v8 offset:3072
  v_cvt_pk_bf16_f32 v72, v64, v65
  v_cvt_pk_bf16_f32 v73, v66, v67
  v_cvt_pk_bf16_f32 v74, v68, v69
  v_cvt_pk_bf16_f32 v75, v70, v71
  s_waitcnt lgkmcnt(2)
  s_nop 0
  v_mfma_f32_16x16x32_bf16 v[148:151], v[72:75], v[76:79], v[148:151]
  ds_write_b16 v248, v243
  ds_read_b128 v[76:79], v5
  ds_write_b16 v248, v18
  ds_read_b64 v[214:215], v9 offset:6344
  s_waitcnt vmcnt(5) lgkmcnt(4)
  v_mfma_f32_16x16x32_bf16 v[64:67], v[56:59], v[36:39], 0
  v_mfma_f32_16x16x32_bf16 v[68:71], v[56:59], v[40:43], 0
  v_and_or_b32 v219, v217, v35, v2
  v_mul_f32 v220, v216, v3
  v_and_b32 v221, 14, v217
  buffer_load_dwordx4 v[56:59], v219, s[4:7], 0 idxen
  v_cos_f32 v220, v220
  v_lshl_add_u32 v248, v221, 3, v4
  v_cvt_pk_bf16_f32 v243, v220, v220
  buffer_store_dwordx4 v[132:135], v6, s[20:23], s43 offen offset:3072 nt
  v_mul_f32 v222, v144, v180
  v_mul_f32 v223, v145, v181
  v_mul_f32 v224, v146, v182
  v_mul_f32 v225, v147, v183
  v_mul_f32_dpp v222, v148, v180 row_ror:8 row_mask:0xf bank_mask:0xc
  v_mul_f32_dpp v223, v149, v181 row_ror:8 row_mask:0xf bank_mask:0xc
  v_mul_f32_dpp v224, v150, v182 row_ror:8 row_mask:0xf bank_mask:0xc
  v_mul_f32_dpp v225, v151, v183 row_ror:8 row_mask:0xf bank_mask:0xc
  v_fmac_f32_dpp v222, v144, v184 row_ror:8 row_mask:0xf bank_mask:0x3
  v_fmac_f32_dpp v223, v145, v185 row_ror:8 row_mask:0xf bank_mask:0x3
  v_fmac_f32_dpp v224, v146, v186 row_ror:8 row_mask:0xf bank_mask:0x3
  v_fmac_f32_dpp v225, v147, v187 row_ror:8 row_mask:0xf bank_mask:0x3
  v_fmac_f32_dpp v222, v148, v184 quad_perm:[0,1,2,3] row_mask:0xf bank_mask:0xc
  v_fmac_f32_dpp v223, v149, v185 quad_perm:[0,1,2,3] row_mask:0xf bank_mask:0xc
  v_fmac_f32_dpp v224, v150, v186 quad_perm:[0,1,2,3] row_mask:0xf bank_mask:0xc
  v_fmac_f32_dpp v225, v151, v187 quad_perm:[0,1,2,3] row_mask:0xf bank_mask:0xc
  v_cvt_pk_bf16_f32 v250, v222, v223
  v_cvt_pk_bf16_f32 v251, v224, v225
  v_mfma_f32_16x16x16_bf16 v[188:191], v[236:237], v[28:29], 0
  v_mfma_f32_16x16x16_bf16 v[180:183], v[226:227], v[28:29], 0
  v_mfma_f32_16x16x16_bf16 v[184:187], v[228:229], v[28:29], 0
  v_mfma_f32_16x16x16_bf16 v[222:225], v[238:239], v[250:251], 0
  v_cvt_pk_bf16_f32 v72, v64, v65
  v_cvt_pk_bf16_f32 v73, v66, v67
  v_cvt_pk_bf16_f32 v74, v68, v69
  v_cvt_pk_bf16_f32 v75, v70, v71
  s_waitcnt lgkmcnt(2)
  s_nop 0
  v_mfma_f32_16x16x32_bf16 v[152:155], v[72:75], v[76:79], v[152:155]
  ds_write_b16 v249, v244
  ds_read_b128 v[76:79], v5
  ds_write_b16 v249, v18
  s_waitcnt vmcnt(6) lgkmcnt(3)
  v_mfma_f32_16x16x32_bf16 v[64:67], v[60:63], v[36:39], 0
  v_mfma_f32_16x16x32_bf16 v[68:71], v[60:63], v[40:43], 0
  v_and_or_b32 v219, v215, v35, v2
  v_mul_f32 v220, v214, v3
  v_and_b32 v221, 14, v215
  buffer_load_dwordx4 v[60:63], v219, s[4:7], 0 idxen
  v_cos_f32 v220, v220
  v_lshl_add_u32 v249, v221, 3, v4
  v_cvt_pk_bf16_f32 v244, v220, v220
  v_lshlrev_b32 v144, 16, v208
  v_and_b32 v145, 0xffff0000, v208
  v_lshlrev_b32 v146, 16, v209
  v_and_b32 v147, 0xffff0000, v209
  v_pk_fma_f32 v[144:145], v[222:223], v[188:189], v[144:145]
  v_pk_fma_f32 v[146:147], v[224:225], v[190:191], v[146:147]
  v_cvt_pk_bf16_f32 v144, v144, v145
  v_cvt_pk_bf16_f32 v145, v146, v147
  ds_write_b64 v7, v[144:145] offset:4096
  v_cvt_pk_bf16_f32 v72, v64, v65
  v_cvt_pk_bf16_f32 v73, v66, v67
  v_cvt_pk_bf16_f32 v74, v68, v69
  v_cvt_pk_bf16_f32 v75, v70, v71
  s_waitcnt lgkmcnt(1)
  s_nop 0
  v_mfma_f32_16x16x32_bf16 v[156:159], v[72:75], v[76:79], v[156:159]
  ds_write_b16 v245, v240
  ds_read_b128 v[76:79], v5
  ds_write_b16 v245, v18
  s_waitcnt vmcnt(5) lgkmcnt(3)
  v_mfma_f32_16x16x32_bf16 v[64:67], v[44:47], v[36:39], 0
  v_mfma_f32_16x16x32_bf16 v[68:71], v[44:47], v[40:43], 0
  v_mul_f32 v222, v152, v180
  v_mul_f32 v223, v153, v181
  v_mul_f32 v224, v154, v182
  v_mul_f32 v225, v155, v183
  v_mul_f32_dpp v222, v156, v180 row_ror:8 row_mask:0xf bank_mask:0xc
  v_mul_f32_dpp v223, v157, v181 row_ror:8 row_mask:0xf bank_mask:0xc
  v_mul_f32_dpp v224, v158, v182 row_ror:8 row_mask:0xf bank_mask:0xc
  v_mul_f32_dpp v225, v159, v183 row_ror:8 row_mask:0xf bank_mask:0xc
  v_fmac_f32_dpp v222, v152, v184 row_ror:8 row_mask:0xf bank_mask:0x3
  v_fmac_f32_dpp v223, v153, v185 row_ror:8 row_mask:0xf bank_mask:0x3
  v_fmac_f32_dpp v224, v154, v186 row_ror:8 row_mask:0xf bank_mask:0x3
  v_fmac_f32_dpp v225, v155, v187 row_ror:8 row_mask:0xf bank_mask:0x3
  v_fmac_f32_dpp v222, v156, v184 quad_perm:[0,1,2,3] row_mask:0xf bank_mask:0xc
  v_fmac_f32_dpp v223, v157, v185 quad_perm:[0,1,2,3] row_mask:0xf bank_mask:0xc
  v_fmac_f32_dpp v224, v158, v186 quad_perm:[0,1,2,3] row_mask:0xf bank_mask:0xc
  v_fmac_f32_dpp v225, v159, v187 quad_perm:[0,1,2,3] row_mask:0xf bank_mask:0xc
  v_cvt_pk_bf16_f32 v250, v222, v223
  v_cvt_pk_bf16_f32 v251, v224, v225
  v_mfma_f32_16x16x16_bf16 v[188:191], v[230:231], v[28:29], 0
  v_mfma_f32_16x16x16_bf16 v[180:183], v[232:233], v[30:31], 0
  v_mfma_f32_16x16x16_bf16 v[184:187], v[234:235], v[30:31], 0
  v_mfma_f32_16x16x16_bf16 v[222:225], v[238:239], v[250:251], 0
  v_cvt_pk_bf16_f32 v72, v64, v65
  v_cvt_pk_bf16_f32 v73, v66, v67
  v_cvt_pk_bf16_f32 v74, v68, v69
  v_cvt_pk_bf16_f32 v75, v70, v71
  s_waitcnt lgkmcnt(1)
  s_nop 0
  v_mfma_f32_16x16x32_bf16 v[160:163], v[72:75], v[76:79], v[160:163]
  ds_write_b16 v246, v241
  ds_read_b128 v[76:79], v5
  ds_write_b16 v246, v18
  s_waitcnt vmcnt(4) lgkmcnt(3)
  v_mfma_f32_16x16x32_bf16 v[64:67], v[48:51], v[36:39], 0
  v_mfma_f32_16x16x32_bf16 v[68:71], v[48:51], v[40:43], 0
  v_lshlrev_b32 v152, 16, v210
  v_and_b32 v153, 0xffff0000, v210
  v_lshlrev_b32 v154, 16, v211
  v_and_b32 v155, 0xffff0000, v211
  v_pk_fma_f32 v[152:153], v[222:223], v[188:189], v[152:153]
  v_pk_fma_f32 v[154:155], v[224:225], v[190:191], v[154:155]
  v_cvt_pk_bf16_f32 v152, v152, v153
  v_cvt_pk_bf16_f32 v153, v154, v155
  ds_write_b64 v7, v[152:153] offset:4608
  ds_read_b128 v[148:151], v8 offset:4096
  v_cvt_pk_bf16_f32 v72, v64, v65
  v_cvt_pk_bf16_f32 v73, v66, v67
  v_cvt_pk_bf16_f32 v74, v68, v69
  v_cvt_pk_bf16_f32 v75, v70, v71
  s_waitcnt lgkmcnt(1)
  s_nop 0
  v_mfma_f32_16x16x32_bf16 v[164:167], v[72:75], v[76:79], v[164:167]
  ds_write_b16 v247, v242
  ds_read_b128 v[76:79], v5
  ds_write_b16 v247, v18
  s_waitcnt vmcnt(3) lgkmcnt(3)
  v_mfma_f32_16x16x32_bf16 v[64:67], v[52:55], v[36:39], 0
  v_mfma_f32_16x16x32_bf16 v[68:71], v[52:55], v[40:43], 0
  buffer_store_dwordx4 v[148:151], v6, s[20:23], s3 offen offset:0 nt
  v_mul_f32 v222, v160, v180
  v_mul_f32 v223, v161, v181
  v_mul_f32 v224, v162, v182
  v_mul_f32 v225, v163, v183
  v_mul_f32_dpp v222, v164, v180 row_ror:8 row_mask:0xf bank_mask:0xc
  v_mul_f32_dpp v223, v165, v181 row_ror:8 row_mask:0xf bank_mask:0xc
  v_mul_f32_dpp v224, v166, v182 row_ror:8 row_mask:0xf bank_mask:0xc
  v_mul_f32_dpp v225, v167, v183 row_ror:8 row_mask:0xf bank_mask:0xc
  v_fmac_f32_dpp v222, v160, v184 row_ror:8 row_mask:0xf bank_mask:0x3
  v_fmac_f32_dpp v223, v161, v185 row_ror:8 row_mask:0xf bank_mask:0x3
  v_fmac_f32_dpp v224, v162, v186 row_ror:8 row_mask:0xf bank_mask:0x3
  v_fmac_f32_dpp v225, v163, v187 row_ror:8 row_mask:0xf bank_mask:0x3
  v_fmac_f32_dpp v222, v164, v184 quad_perm:[0,1,2,3] row_mask:0xf bank_mask:0xc
  v_fmac_f32_dpp v223, v165, v185 quad_perm:[0,1,2,3] row_mask:0xf bank_mask:0xc
  v_fmac_f32_dpp v224, v166, v186 quad_perm:[0,1,2,3] row_mask:0xf bank_mask:0xc
  v_fmac_f32_dpp v225, v167, v187 quad_perm:[0,1,2,3] row_mask:0xf bank_mask:0xc
  v_cvt_pk_bf16_f32 v250, v222, v223
  v_cvt_pk_bf16_f32 v251, v224, v225
  v_mfma_f32_16x16x16_bf16 v[188:191], v[236:237], v[30:31], 0
  v_mfma_f32_16x16x16_bf16 v[180:183], v[226:227], v[30:31], 0
  v_mfma_f32_16x16x16_bf16 v[184:187], v[228:229], v[30:31], 0
  v_mfma_f32_16x16x16_bf16 v[222:225], v[238:239], v[250:251], 0
  v_cvt_pk_bf16_f32 v72, v64, v65
  v_cvt_pk_bf16_f32 v73, v66, v67
  v_cvt_pk_bf16_f32 v74, v68, v69
  v_cvt_pk_bf16_f32 v75, v70, v71
  s_waitcnt lgkmcnt(1)
  s_nop 0
  v_mfma_f32_16x16x32_bf16 v[168:171], v[72:75], v[76:79], v[168:171]
  ds_write_b16 v248, v243
  ds_read_b128 v[76:79], v5
  ds_write_b16 v248, v18
  s_waitcnt vmcnt(3) lgkmcnt(3)
  v_mfma_f32_16x16x32_bf16 v[64:67], v[56:59], v[36:39], 0
  v_mfma_f32_16x16x32_bf16 v[68:71], v[56:59], v[40:43], 0
  v_lshlrev_b32 v160, 16, v212
  v_and_b32 v161, 0xffff0000, v212
  v_lshlrev_b32 v162, 16, v213
  v_and_b32 v163, 0xffff0000, v213
  v_pk_fma_f32 v[160:161], v[222:223], v[188:189], v[160:161]
  v_pk_fma_f32 v[162:163], v[224:225], v[190:191], v[162:163]
  v_cvt_pk_bf16_f32 v160, v160, v161
  v_cvt_pk_bf16_f32 v161, v162, v163
  ds_write_b64 v7, v[160:161] offset:5120
  v_cvt_pk_bf16_f32 v72, v64, v65
  v_cvt_pk_bf16_f32 v73, v66, v67
  v_cvt_pk_bf16_f32 v74, v68, v69
  v_cvt_pk_bf16_f32 v75, v70, v71
  s_waitcnt lgkmcnt(1)
  s_nop 0
  v_mfma_f32_16x16x32_bf16 v[172:175], v[72:75], v[76:79], v[172:175]
  ds_write_b16 v249, v244
  ds_read_b128 v[76:79], v5
  ds_write_b16 v249, v18
  s_waitcnt vmcnt(1) lgkmcnt(3)
  v_mfma_f32_16x16x32_bf16 v[64:67], v[60:63], v[36:39], 0
  v_mfma_f32_16x16x32_bf16 v[68:71], v[60:63], v[40:43], 0
  v_mul_f32 v222, v168, v180
  v_mul_f32 v223, v169, v181
  v_mul_f32 v224, v170, v182
  v_mul_f32 v225, v171, v183
  v_mul_f32_dpp v222, v172, v180 row_ror:8 row_mask:0xf bank_mask:0xc
  v_mul_f32_dpp v223, v173, v181 row_ror:8 row_mask:0xf bank_mask:0xc
  v_mul_f32_dpp v224, v174, v182 row_ror:8 row_mask:0xf bank_mask:0xc
  v_mul_f32_dpp v225, v175, v183 row_ror:8 row_mask:0xf bank_mask:0xc
  v_fmac_f32_dpp v222, v168, v184 row_ror:8 row_mask:0xf bank_mask:0x3
  v_fmac_f32_dpp v223, v169, v185 row_ror:8 row_mask:0xf bank_mask:0x3
  v_fmac_f32_dpp v224, v170, v186 row_ror:8 row_mask:0xf bank_mask:0x3
  v_fmac_f32_dpp v225, v171, v187 row_ror:8 row_mask:0xf bank_mask:0x3
  v_fmac_f32_dpp v222, v172, v184 quad_perm:[0,1,2,3] row_mask:0xf bank_mask:0xc
  v_fmac_f32_dpp v223, v173, v185 quad_perm:[0,1,2,3] row_mask:0xf bank_mask:0xc
  v_fmac_f32_dpp v224, v174, v186 quad_perm:[0,1,2,3] row_mask:0xf bank_mask:0xc
  v_fmac_f32_dpp v225, v175, v187 quad_perm:[0,1,2,3] row_mask:0xf bank_mask:0xc
  v_cvt_pk_bf16_f32 v250, v222, v223
  v_cvt_pk_bf16_f32 v251, v224, v225
  v_mfma_f32_16x16x16_bf16 v[188:191], v[230:231], v[30:31], 0
  v_mfma_f32_16x16x16_bf16 v[180:183], v[232:233], v[32:33], 0
  v_mfma_f32_16x16x16_bf16 v[184:187], v[234:235], v[32:33], 0
  v_mfma_f32_16x16x16_bf16 v[222:225], v[238:239], v[250:251], 0
  v_cvt_pk_bf16_f32 v72, v64, v65
  v_cvt_pk_bf16_f32 v73, v66, v67
  v_cvt_pk_bf16_f32 v74, v68, v69
  v_cvt_pk_bf16_f32 v75, v70, v71
  s_waitcnt lgkmcnt(1)
  s_nop 0
  v_mfma_f32_16x16x32_bf16 v[176:179], v[72:75], v[76:79], v[176:179]
  s_nop 3
  s_waitcnt lgkmcnt(0)
  v_lshlrev_b32 v168, 16, v252
  v_and_b32 v169, 0xffff0000, v252
  v_lshlrev_b32 v170, 16, v253
  v_and_b32 v171, 0xffff0000, v253
  v_pk_fma_f32 v[168:169], v[222:223], v[188:189], v[168:169]
  v_pk_fma_f32 v[170:171], v[224:225], v[190:191], v[170:171]
  v_cvt_pk_bf16_f32 v168, v168, v169
  v_cvt_pk_bf16_f32 v169, v170, v171
  ds_write_b64 v7, v[168:169] offset:5632
  ds_read_b128 v[164:167], v8 offset:5120
  v_mul_f32 v222, v176, v180
  v_mul_f32 v223, v177, v181
  v_mul_f32 v224, v178, v182
  v_mul_f32 v225, v179, v183
  v_mul_f32_dpp v222, v176, v180 row_ror:8 row_mask:0xf bank_mask:0xc
  v_mul_f32_dpp v223, v177, v181 row_ror:8 row_mask:0xf bank_mask:0xc
  v_mul_f32_dpp v224, v178, v182 row_ror:8 row_mask:0xf bank_mask:0xc
  v_mul_f32_dpp v225, v179, v183 row_ror:8 row_mask:0xf bank_mask:0xc
  v_fmac_f32_dpp v222, v176, v184 row_ror:8 row_mask:0xf bank_mask:0x3
  v_fmac_f32_dpp v223, v177, v185 row_ror:8 row_mask:0xf bank_mask:0x3
  v_fmac_f32_dpp v224, v178, v186 row_ror:8 row_mask:0xf bank_mask:0x3
  v_fmac_f32_dpp v225, v179, v187 row_ror:8 row_mask:0xf bank_mask:0x3
  v_fmac_f32_dpp v222, v176, v184 quad_perm:[0,1,2,3] row_mask:0xf bank_mask:0xc
  v_fmac_f32_dpp v223, v177, v185 quad_perm:[0,1,2,3] row_mask:0xf bank_mask:0xc
  v_fmac_f32_dpp v224, v178, v186 quad_perm:[0,1,2,3] row_mask:0xf bank_mask:0xc
  v_fmac_f32_dpp v225, v179, v187 quad_perm:[0,1,2,3] row_mask:0xf bank_mask:0xc
  v_cvt_pk_bf16_f32 v250, v222, v223
  v_cvt_pk_bf16_f32 v251, v224, v225
  v_mfma_f32_16x16x16_bf16 v[188:191], v[236:237], v[32:33], 0
  s_nop 0
  v_mfma_f32_16x16x16_bf16 v[222:225], v[238:239], v[250:251], 0
  s_waitcnt lgkmcnt(0)
  buffer_store_dwordx4 v[164:167], v6, s[20:23], s3 offen offset:1024 nt
  v_lshlrev_b32 v176, 16, v254
  v_and_b32 v177, 0xffff0000, v254
  v_lshlrev_b32 v178, 16, v255
  v_and_b32 v179, 0xffff0000, v255
  s_nop 3
  v_pk_fma_f32 v[176:177], v[222:223], v[188:189], v[176:177]
  v_pk_fma_f32 v[178:179], v[224:225], v[190:191], v[178:179]
  v_cvt_pk_bf16_f32 v176, v176, v177
  v_cvt_pk_bf16_f32 v177, v178, v179
  s_mov_b64 exec, s[76:77]
  ds_write_b64 v7, v[176:177] offset:6144
  s_mov_b64 exec, -1
  ds_read_b128 v[172:175], v8 offset:6144
  s_waitcnt lgkmcnt(0)
  buffer_store_dwordx4 v[172:175], v6, s[20:23], s3 offen offset:2048 nt
L_end:
  s_endpgm
L_x1:
  v_cmp_gt_u32 vcc, s40, v1
  v_lshlrev_b32 v218, 3, v1
  s_nop 0
  v_cndmask_b32 v218, v12, v218, vcc
  buffer_load_dwordx2 v[250:251], v218, s[12:15], s38 offen sc1
  s_branch L_x1_back
L_x2:
  s_mul_i32 s41, s33, 25
  s_waitcnt vmcnt(3)
  v_min_i32 v222, v250, v251
  v_cmp_gt_i32 vcc, 0, v250
  v_bfe_u32 v224, v222, 23, 8
  v_subrev_u32 v224, s41, v224
  v_cndmask_b32_sdwa v223, v250, v251, vcc dst_sel:WORD_1 dst_unused:UNUSED_PAD src0_sel:WORD_1 src1_sel:WORD_0
  v_cmp_gt_i32 s[74:75], 0, v222
  v_cmp_gt_u32 s[72:73], 25, v224
  s_and_b64 vcc, s[72:73], s[74:75]
  s_cselect_b32 s40, s40, 0
  s_cbranch_scc0 L_x2_back
  v_and_or_b32 v218, v222, v35, v2
  v_mul_f32 v223, v223, v3
  s_mov_b32 m0, s44
  v_cndmask_b32 v218, v35, v218, vcc
  buffer_load_dwordx4 v[188:191], v218, s[4:7], 0 idxen
  v_cndmask_b32 v224, v12, v224, vcc
  v_cos_f32 v223, v223
  v_and_b32 v225, 14, v222
  v_lshl_add_u32 v225, v225, 3, v4
  v_cvt_pk_bf16_f32 v223, v223, v223
  s_branch L_x2_back
L_x3:
  s_waitcnt vmcnt(2)
  v_mfma_f32_16x16x32_bf16 v[64:67], v[188:191], v[36:39], 0
  v_mfma_f32_16x16x32_bf16 v[68:71], v[188:191], v[40:43], 0
  s_nop 6
  v_cvt_pk_bf16_f32 v72, v64, v65
  v_cvt_pk_bf16_f32 v73, v66, v67
  v_cvt_pk_bf16_f32 v74, v68, v69
  v_cvt_pk_bf16_f32 v75, v70, v71
  v_cmp_eq_u32 vcc, 0, v224
  s_cbranch_vccz L_x3_0
  s_mov_b64 exec, vcc
  ds_write_b16 v225, v223
  s_mov_b64 exec, -1
  ds_read_b128 v[76:79], v5
  s_mov_b64 exec, vcc
  ds_write_b16 v225, v18
  s_mov_b64 exec, -1
  s_waitcnt lgkmcnt(0)
  v_mfma_f32_16x16x32_bf16 v[80:83], v[72:75], v[76:79], v[80:83]
L_x3_0:
  v_cmp_eq_u32 vcc, 1, v224
  s_cbranch_vccz L_x3_1
  s_mov_b64 exec, vcc
  ds_write_b16 v225, v223
  s_mov_b64 exec, -1
  ds_read_b128 v[76:79], v5
  s_mov_b64 exec, vcc
  ds_write_b16 v225, v18
  s_mov_b64 exec, -1
  s_waitcnt lgkmcnt(0)
  v_mfma_f32_16x16x32_bf16 v[84:87], v[72:75], v[76:79], v[84:87]
L_x3_1:
  v_cmp_eq_u32 vcc, 2, v224
  s_cbranch_vccz L_x3_2
  s_mov_b64 exec, vcc
  ds_write_b16 v225, v223
  s_mov_b64 exec, -1
  ds_read_b128 v[76:79], v5
  s_mov_b64 exec, vcc
  ds_write_b16 v225, v18
  s_mov_b64 exec, -1
  s_waitcnt lgkmcnt(0)
  v_mfma_f32_16x16x32_bf16 v[88:91], v[72:75], v[76:79], v[88:91]
L_x3_2:
  v_cmp_eq_u32 vcc, 3, v224
  s_cbranch_vccz L_x3_3
  s_mov_b64 exec, vcc
  ds_write_b16 v225, v223
  s_mov_b64 exec, -1
  ds_read_b128 v[76:79], v5
  s_mov_b64 exec, vcc
  ds_write_b16 v225, v18
  s_mov_b64 exec, -1
  s_waitcnt lgkmcnt(0)
  v_mfma_f32_16x16x32_bf16 v[92:95], v[72:75], v[76:79], v[92:95]
L_x3_3:
  v_cmp_eq_u32 vcc, 4, v224
  s_cbranch_vccz L_x3_4
  s_mov_b64 exec, vcc
  ds_write_b16 v225, v223
  s_mov_b64 exec, -1
  ds_read_b128 v[76:79], v5
  s_mov_b64 exec, vcc
  ds_write_b16 v225, v18
  s_mov_b64 exec, -1
  s_waitcnt lgkmcnt(0)
  v_mfma_f32_16x16x32_bf16 v[96:99], v[72:75], v[76:79], v[96:99]
L_x3_4:
  v_cmp_eq_u32 vcc, 5, v224
  s_cbranch_vccz L_x3_5
  s_mov_b64 exec, vcc
  ds_write_b16 v225, v223
  s_mov_b64 exec, -1
  ds_read_b128 v[76:79], v5
  s_mov_b64 exec, vcc
  ds_write_b16 v225, v18
  s_mov_b64 exec, -1
  s_waitcnt lgkmcnt(0)
  v_mfma_f32_16x16x32_bf16 v[100:103], v[72:75], v[76:79], v[100:103]
L_x3_5:
  v_cmp_eq_u32 vcc, 6, v224
  s_cbranch_vccz L_x3_6
  s_mov_b64 exec, vcc
  ds_write_b16 v225, v223
  s_mov_b64 exec, -1
  ds_read_b128 v[76:79], v5
  s_mov_b64 exec, vcc
  ds_write_b16 v225, v18
  s_mov_b64 exec, -1
  s_waitcnt lgkmcnt(0)
  v_mfma_f32_16x16x32_bf16 v[104:107], v[72:75], v[76:79], v[104:107]
L_x3_6:
  v_cmp_eq_u32 vcc, 7, v224
  s_cbranch_vccz L_x3_7
  s_mov_b64 exec, vcc
  ds_write_b16 v225, v223
  s_mov_b64 exec, -1
  ds_read_b128 v[76:79], v5
  s_mov_b64 exec, vcc
  ds_write_b16 v225, v18
  s_mov_b64 exec, -1
  s_waitcnt lgkmcnt(0)
  v_mfma_f32_16x16x32_bf16 v[108:111], v[72:75], v[76:79], v[108:111]
L_x3_7:
  v_cmp_eq_u32 vcc, 8, v224
  s_cbranch_vccz L_x3_8
  s_mov_b64 exec, vcc
  ds_write_b16 v225, v223
  s_mov_b64 exec, -1
  ds_read_b128 v[76:79], v5
  s_mov_b64 exec, vcc
  ds_write_b16 v225, v18
  s_mov_b64 exec, -1
  s_waitcnt lgkmcnt(0)
  v_mfma_f32_16x16x32_bf16 v[112:115], v[72:75], v[76:79], v[112:115]
L_x3_8:
  v_cmp_eq_u32 vcc, 9, v224
  s_cbranch_vccz L_x3_9
  s_mov_b64 exec, vcc
  ds_write_b16 v225, v223
  s_mov_b64 exec, -1
  ds_read_b128 v[76:79], v5
  s_mov_b64 exec, vcc
  ds_write_b16 v225, v18
  s_mov_b64 exec, -1
  s_waitcnt lgkmcnt(0)
  v_mfma_f32_16x16x32_bf16 v[116:119], v[72:75], v[76:79], v[116:119]
L_x3_9:
  v_cmp_eq_u32 vcc, 10, v224
  s_cbranch_vccz L_x3_10
  s_mov_b64 exec, vcc
  ds_write_b16 v225, v223
  s_mov_b64 exec, -1
  ds_read_b128 v[76:79], v5
  s_mov_b64 exec, vcc
  ds_write_b16 v225, v18
  s_mov_b64 exec, -1
  s_waitcnt lgkmcnt(0)
  v_mfma_f32_16x16x32_bf16 v[120:123], v[72:75], v[76:79], v[120:123]
L_x3_10:
  v_cmp_eq_u32 vcc, 11, v224
  s_cbranch_vccz L_x3_11
  s_mov_b64 exec, vcc
  ds_write_b16 v225, v223
  s_mov_b64 exec, -1
  ds_read_b128 v[76:79], v5
  s_mov_b64 exec, vcc
  ds_write_b16 v225, v18
  s_mov_b64 exec, -1
  s_waitcnt lgkmcnt(0)
  v_mfma_f32_16x16x32_bf16 v[124:127], v[72:75], v[76:79], v[124:127]
L_x3_11:
  v_cmp_eq_u32 vcc, 12, v224
  s_cbranch_vccz L_x3_12
  s_mov_b64 exec, vcc
  ds_write_b16 v225, v223
  s_mov_b64 exec, -1
  ds_read_b128 v[76:79], v5
  s_mov_b64 exec, vcc
  ds_write_b16 v225, v18
  s_mov_b64 exec, -1
  s_waitcnt lgkmcnt(0)
  v_mfma_f32_16x16x32_bf16 v[128:131], v[72:75], v[76:79], v[128:131]
L_x3_12:
  v_cmp_eq_u32 vcc, 13, v224
  s_cbranch_vccz L_x3_13
  s_mov_b64 exec, vcc
  ds_write_b16 v225, v223
  s_mov_b64 exec, -1
  ds_read_b128 v[76:79], v5
  s_mov_b64 exec, vcc
  ds_write_b16 v225, v18
  s_mov_b64 exec, -1
  s_waitcnt lgkmcnt(0)
  v_mfma_f32_16x16x32_bf16 v[132:135], v[72:75], v[76:79], v[132:135]
L_x3_13:
  v_cmp_eq_u32 vcc, 14, v224
  s_cbranch_vccz L_x3_14
  s_mov_b64 exec, vcc
  ds_write_b16 v225, v223
  s_mov_b64 exec, -1
  ds_read_b128 v[76:79], v5
  s_mov_b64 exec, vcc
  ds_write_b16 v225, v18
  s_mov_b64 exec, -1
  s_waitcnt lgkmcnt(0)
  v_mfma_f32_16x16x32_bf16 v[136:139], v[72:75], v[76:79], v[136:139]
L_x3_14:
  v_cmp_eq_u32 vcc, 15, v224
  s_cbranch_vccz L_x3_15
  s_mov_b64 exec, vcc
  ds_write_b16 v225, v223
  s_mov_b64 exec, -1
  ds_read_b128 v[76:79], v5
  s_mov_b64 exec, vcc
  ds_write_b16 v225, v18
  s_mov_b64 exec, -1
  s_waitcnt lgkmcnt(0)
  v_mfma_f32_16x16x32_bf16 v[140:143], v[72:75], v[76:79], v[140:143]
L_x3_15:
  v_cmp_eq_u32 vcc, 16, v224
  s_cbranch_vccz L_x3_16
  s_mov_b64 exec, vcc
  ds_write_b16 v225, v223
  s_mov_b64 exec, -1
  ds_read_b128 v[76:79], v5
  s_mov_b64 exec, vcc
  ds_write_b16 v225, v18
  s_mov_b64 exec, -1
  s_waitcnt lgkmcnt(0)
  v_mfma_f32_16x16x32_bf16 v[144:147], v[72:75], v[76:79], v[144:147]
L_x3_16:
  v_cmp_eq_u32 vcc, 17, v224
  s_cbranch_vccz L_x3_17
  s_mov_b64 exec, vcc
  ds_write_b16 v225, v223
  s_mov_b64 exec, -1
  ds_read_b128 v[76:79], v5
  s_mov_b64 exec, vcc
  ds_write_b16 v225, v18
  s_mov_b64 exec, -1
  s_waitcnt lgkmcnt(0)
  v_mfma_f32_16x16x32_bf16 v[148:151], v[72:75], v[76:79], v[148:151]
L_x3_17:
  v_cmp_eq_u32 vcc, 18, v224
  s_cbranch_vccz L_x3_18
  s_mov_b64 exec, vcc
  ds_write_b16 v225, v223
  s_mov_b64 exec, -1
  ds_read_b128 v[76:79], v5
  s_mov_b64 exec, vcc
  ds_write_b16 v225, v18
  s_mov_b64 exec, -1
  s_waitcnt lgkmcnt(0)
  v_mfma_f32_16x16x32_bf16 v[152:155], v[72:75], v[76:79], v[152:155]
L_x3_18:
  v_cmp_eq_u32 vcc, 19, v224
  s_cbranch_vccz L_x3_19
  s_mov_b64 exec, vcc
  ds_write_b16 v225, v223
  s_mov_b64 exec, -1
  ds_read_b128 v[76:79], v5
  s_mov_b64 exec, vcc
  ds_write_b16 v225, v18
  s_mov_b64 exec, -1
  s_waitcnt lgkmcnt(0)
  v_mfma_f32_16x16x32_bf16 v[156:159], v[72:75], v[76:79], v[156:159]
L_x3_19:
  v_cmp_eq_u32 vcc, 20, v224
  s_cbranch_vccz L_x3_20
  s_mov_b64 exec, vcc
  ds_write_b16 v225, v223
  s_mov_b64 exec, -1
  ds_read_b128 v[76:79], v5
  s_mov_b64 exec, vcc
  ds_write_b16 v225, v18
  s_mov_b64 exec, -1
  s_waitcnt lgkmcnt(0)
  v_mfma_f32_16x16x32_bf16 v[160:163], v[72:75], v[76:79], v[160:163]
L_x3_20:
  v_cmp_eq_u32 vcc, 21, v224
  s_cbranch_vccz L_x3_21
  s_mov_b64 exec, vcc
  ds_write_b16 v225, v223
  s_mov_b64 exec, -1
  ds_read_b128 v[76:79], v5
  s_mov_b64 exec, vcc
  ds_write_b16 v225, v18
  s_mov_b64 exec, -1
  s_waitcnt lgkmcnt(0)
  v_mfma_f32_16x16x32_bf16 v[164:167], v[72:75], v[76:79], v[164:167]
L_x3_21:
  v_cmp_eq_u32 vcc, 22, v224
  s_cbranch_vccz L_x3_22
  s_mov_b64 exec, vcc
  ds_write_b16 v225, v223
  s_mov_b64 exec, -1
  ds_read_b128 v[76:79], v5
  s_mov_b64 exec, vcc
  ds_write_b16 v225, v18
  s_mov_b64 exec, -1
  s_waitcnt lgkmcnt(0)
  v_mfma_f32_16x16x32_bf16 v[168:171], v[72:75], v[76:79], v[168:171]
L_x3_22:
  v_cmp_eq_u32 vcc, 23, v224
  s_cbranch_vccz L_x3_23
  s_mov_b64 exec, vcc
  ds_write_b16 v225, v223
  s_mov_b64 exec, -1
  ds_read_b128 v[76:79], v5
  s_mov_b64 exec, vcc
  ds_write_b16 v225, v18
  s_mov_b64 exec, -1
  s_waitcnt lgkmcnt(0)
  v_mfma_f32_16x16x32_bf16 v[172:175], v[72:75], v[76:79], v[172:175]
L_x3_23:
  v_cmp_eq_u32 vcc, 24, v224
  s_cbranch_vccz L_x3_24
  s_mov_b64 exec, vcc
  ds_write_b16 v225, v223
  s_mov_b64 exec, -1
  ds_read_b128 v[76:79], v5
  s_mov_b64 exec, vcc
  ds_write_b16 v225, v18
  s_mov_b64 exec, -1
  s_waitcnt lgkmcnt(0)
  v_mfma_f32_16x16x32_bf16 v[176:179], v[72:75], v[76:79], v[176:179]
L_x3_24:
  s_branch L_x3_back
L_mld:
  v_bfe_u32 v218, v0, 4, 2
  v_and_b32 v219, 15, v0
  v_lshlrev_b32 v218, 3, v218
  v_lshl_add_u32 v218, v219, 5, v218
  buffer_load_dwordx2 v[192:193], v218, s[28:31], s43 offen offset:0
  buffer_load_dwordx2 v[194:195], v218, s[28:31], s43 offen offset:512
  buffer_load_dwordx2 v[196:197], v218, s[28:31], s43 offen offset:1024
  buffer_load_dwordx2 v[198:199], v218, s[28:31], s43 offen offset:1536
  buffer_load_dwordx2 v[200:201], v218, s[28:31], s43 offen offset:2048
  buffer_load_dwordx2 v[202:203], v218, s[28:31], s43 offen offset:2560
  buffer_load_dwordx2 v[204:205], v218, s[28:31], s43 offen offset:3072
  buffer_load_dwordx2 v[206:207], v218, s[28:31], s43 offen offset:3584
  buffer_load_dwordx2 v[208:209], v218, s[28:31], s3 offen offset:0
  buffer_load_dwordx2 v[210:211], v218, s[28:31], s3 offen offset:512
  buffer_load_dwordx2 v[212:213], v218, s[28:31], s3 offen offset:1024
  buffer_load_dwordx2 v[252:253], v218, s[28:31], s3 offen offset:1536
  buffer_load_dwordx2 v[254:255], v218, s[28:31], s3 offen offset:2048
  s_cmp_eq_u32 s45, -1
  s_cbranch_scc1 L_mld_back2
  s_branch L_mld_back1
L_it0:
  v_mov_b32 v222, 114720
  s_waitcnt vmcnt(0)
  s_mov_b64 exec, 1
  ds_add_rtn_u32 v223, v222, v11
  s_mov_b64 exec, -1
  v_and_b32 v224, 63, v0
  s_lshl_b32 s41, s2, 2
  v_lshl_add_u32 v224, v224, 10, s41
  v_mov_b32 v225, 4
  s_waitcnt lgkmcnt(0)
  v_readfirstlane_b32 s41, v223
  s_cmp_lg_u32 s41, 7
  s_cbranch_scc1 L_nosig_z0
  buffer_store_dword v225, v224, s[92:95], 0 offen sc1
L_nosig_z0:
  s_branch L_nosig_z
L_sig:
  v_mov_b32 v222, 114720
  s_waitcnt vmcnt(7)
  s_mov_b64 exec, 1
  ds_add_rtn_u32 v223, v222, v11
  s_mov_b64 exec, -1
  v_and_b32 v224, 63, v0
  s_lshl_b32 s41, s2, 2
  v_lshl_add_u32 v224, v224, 10, s41
  v_mov_b32 v225, 4
  s_waitcnt lgkmcnt(0)
  v_readfirstlane_b32 s41, v223
  s_cmp_lg_u32 s41, 7
  s_cbranch_scc1 L_nosig_b1
  buffer_store_dword v225, v224, s[92:95], 0 offen sc1
L_nosig_b1:
  s_branch L_nosig_b0
L_ldc:
  v_lshlrev_b32 v184, 4, v0
  s_and_b32 s41, s2, 3
  s_lshl_b32 s41, s41, 10
  buffer_load_dwordx4 v[180:183], v184, s[92:95], s41 offen sc1
  s_branch L_ldc_back
L_chkc:
  s_waitcnt vmcnt(4)
  v_min3_u32 v180, v180, v181, v182
  v_min_u32 v180, v180, v183
  v_cmp_gt_u32 vcc, 4, v180
  s_cbranch_vccz L_turn2
  s_and_b32 s41, s2, 3
  s_lshl_b32 s41, s41, 10
  s_mov_b32 s100, 60000
L_poll_c:
  buffer_load_dwordx4 v[180:183], v184, s[92:95], s41 offen sc1
  s_waitcnt vmcnt(0)
  v_min3_u32 v180, v180, v181, v182
  v_min_u32 v180, v180, v183
  v_cmp_gt_u32 vcc, 4, v180
  s_cbranch_vccz L_polled_c
  s_sleep 8
  s_sub_u32 s100, s100, 1
  s_cbranch_scc0 L_poll_c
L_polled_c:
  s_branch L_turn2
L_borrow:
  v_lshrrev_b32 v218, 16, v23
  v_cmp_eq_u32 vcc, 0, v27
  v_subrev_u32 v219, 24, v218
  v_and_b32 v220, 0xffff, v23
  v_max_i32 v219, 0, v219
  v_cndmask_b32 v219, v18, v219, vcc
  v_add_u32 v220, v220, v218
  v_sub_u32 v220, v220, v219
  v_cndmask_b32 v26, v26, v220, vcc
  v_add_u32 v27, v27, v219
  v_lshlrev_b32 v219, 16, v219
  v_sub_u32 v23, v23, v219
  s_branch L_borrow_back
L_two_0:
  v_sub_co_u32_dpp v224, vcc, v33, v7 row_newbcast:0 row_mask:0xf bank_mask:0xf
  v_add_u32_dpp v224, v31, v6 row_newbcast:0 row_mask:0xf bank_mask:0xf
  s_nop 0
  v_cndmask_b32 v222, v224, v222, vcc
  s_branch L_two_back_0
L_two_1:
  v_sub_co_u32_dpp v224, vcc, v33, v7 row_newbcast:1 row_mask:0xf bank_mask:0xf
  v_add_u32_dpp v224, v31, v6 row_newbcast:1 row_mask:0xf bank_mask:0xf
  s_nop 0
  v_cndmask_b32 v222, v224, v222, vcc
  s_branch L_two_back_1
L_two_2:
  v_sub_co_u32_dpp v224, vcc, v33, v7 row_newbcast:2 row_mask:0xf bank_mask:0xf
  v_add_u32_dpp v224, v31, v6 row_newbcast:2 row_mask:0xf bank_mask:0xf
  s_nop 0
  v_cndmask_b32 v222, v224, v222, vcc
  s_branch L_two_back_2
L_two_3:
  v_sub_co_u32_dpp v224, vcc, v33, v7 row_newbcast:3 row_mask:0xf bank_mask:0xf
  v_add_u32_dpp v224, v31, v6 row_newbcast:3 row_mask:0xf bank_mask:0xf
  s_nop 0
  v_cndmask_b32 v222, v224, v222, vcc
  s_branch L_two_back_3
L_two_4:
  v_sub_co_u32_dpp v224, vcc, v33, v7 row_newbcast:4 row_mask:0xf bank_mask:0xf
  v_add_u32_dpp v224, v31, v6 row_newbcast:4 row_mask:0xf bank_mask:0xf
  s_nop 0
  v_cndmask_b32 v222, v224, v222, vcc
  s_branch L_two_back_4
L_two_5:
  v_sub_co_u32_dpp v224, vcc, v33, v7 row_newbcast:5 row_mask:0xf bank_mask:0xf
  v_add_u32_dpp v224, v31, v6 row_newbcast:5 row_mask:0xf bank_mask:0xf
  s_nop 0
  v_cndmask_b32 v222, v224, v222, vcc
  s_branch L_two_back_5
L_two_6:
  v_sub_co_u32_dpp v224, vcc, v33, v7 row_newbcast:6 row_mask:0xf bank_mask:0xf
  v_add_u32_dpp v224, v31, v6 row_newbcast:6 row_mask:0xf bank_mask:0xf
  s_nop 0
  v_cndmask_b32 v222, v224, v222, vcc
  s_branch L_two_back_6
L_two_7:
  v_sub_co_u32_dpp v224, vcc, v33, v7 row_newbcast:7 row_mask:0xf bank_mask:0xf
  v_add_u32_dpp v224, v31, v6 row_newbcast:7 row_mask:0xf bank_mask:0xf
  s_nop 0
  v_cndmask_b32 v222, v224, v222, vcc
  s_branch L_two_back_7
L_two_8:
  v_sub_co_u32_dpp v224, vcc, v33, v7 row_newbcast:8 row_mask:0xf bank_mask:0xf
  v_add_u32_dpp v224, v31, v6 row_newbcast:8 row_mask:0xf bank_mask:0xf
  s_nop 0
  v_cndmask_b32 v222, v224, v222, vcc
  s_branch L_two_back_8
L_two_9:
  v_sub_co_u32_dpp v224, vcc, v33, v7 row_newbcast:9 row_mask:0xf bank_mask:0xf
  v_add_u32_dpp v224, v31, v6 row_newbcast:9 row_mask:0xf bank_mask:0xf
  s_nop 0
  v_cndmask_b32 v222, v224, v222, vcc
  s_branch L_two_back_9
L_two_10:
  v_sub_co_u32_dpp v224, vcc, v33, v7 row_newbcast:10 row_mask:0xf bank_mask:0xf
  v_add_u32_dpp v224, v31, v6 row_newbcast:10 row_mask:0xf bank_mask:0xf
  s_nop 0
  v_cndmask_b32 v222, v224, v222, vcc
  s_branch L_two_back_10
L_two_11:
  v_sub_co_u32_dpp v224, vcc, v33, v7 row_newbcast:11 row_mask:0xf bank_mask:0xf
  v_add_u32_dpp v224, v31, v6 row_newbcast:11 row_mask:0xf bank_mask:0xf
  s_nop 0
  v_cndmask_b32 v222, v224, v222, vcc
  s_branch L_two_back_11
L_two_12:
  v_sub_co_u32_dpp v224, vcc, v33, v7 row_newbcast:12 row_mask:0xf bank_mask:0xf
  v_add_u32_dpp v224, v31, v6 row_newbcast:12 row_mask:0xf bank_mask:0xf
  s_nop 0
  v_cndmask_b32 v222, v224, v222, vcc
  s_branch L_two_back_12
L_two_13:
  v_sub_co_u32_dpp v224, vcc, v33, v7 row_newbcast:13 row_mask:0xf bank_mask:0xf
  v_add_u32_dpp v224, v31, v6 row_newbcast:13 row_mask:0xf bank_mask:0xf
  s_nop 0
  v_cndmask_b32 v222, v224, v222, vcc
  s_branch L_two_back_13
L_two_14:
  v_sub_co_u32_dpp v224, vcc, v33, v7 row_newbcast:14 row_mask:0xf bank_mask:0xf
  v_add_u32_dpp v224, v31, v6 row_newbcast:14 row_mask:0xf bank_mask:0xf
  s_nop 0
  v_cndmask_b32 v222, v224, v222, vcc
  s_branch L_two_back_14
L_two_15:
  v_sub_co_u32_dpp v224, vcc, v33, v7 row_newbcast:15 row_mask:0xf bank_mask:0xf
  v_add_u32_dpp v224, v31, v6 row_newbcast:15 row_mask:0xf bank_mask:0xf
  s_nop 0
  v_cndmask_b32 v222, v224, v222, vcc
  s_branch L_two_back_15
L_allfirst:
  s_mov_b32 s100, s101
  buffer_store_dwordx4 v[120:123], v250, s[96:99], s101 offen sc1
  s_add_u32 s101, s101, 8192
  buffer_store_dwordx4 v[124:127], v250, s[96:99], s101 offen sc1
  s_add_u32 s101, s101, 8192
  buffer_store_dwordx4 v[128:131], v250, s[96:99], s101 offen sc1
  s_add_u32 s101, s101, 8192
  buffer_store_dwordx4 v[132:135], v250, s[96:99], s101 offen sc1
  s_add_u32 s101, s101, 8192
  buffer_store_dwordx4 v[136:139], v250, s[96:99], s101 offen sc1
  s_add_u32 s101, s101, 8192
  buffer_store_dwordx4 v[140:143], v250, s[96:99], s101 offen sc1
  s_add_u32 s101, s101, 8192
  buffer_store_dwordx4 v[144:147], v250, s[96:99], s101 offen sc1
  s_add_u32 s101, s101, 8192
  buffer_store_dwordx4 v[148:151], v250, s[96:99], s101 offen sc1
  s_add_u32 s101, s101, 8192
  buffer_store_dwordx4 v[152:155], v250, s[96:99], s101 offen sc1
  s_add_u32 s101, s101, 8192
  buffer_store_dwordx4 v[156:159], v250, s[96:99], s101 offen sc1
  s_add_u32 s101, s101, 8192
  s_mov_b32 s101, s100
  s_waitcnt vmcnt(0)
  s_barrier
  buffer_store_dword v241, v240, s[92:95], 0 offen sc1
  s_branch L_allfirst_back
L_pslow_0:
  s_mov_b64 exec, s[72:73]
  v_cmp_lt_u32 vcc, 63, v44
  s_cbranch_vccz L_pskip_0_0
  s_andn2_b64 s[72:73], s[72:73], vcc
  s_mov_b64 exec, vcc
  ds_add_rtn_u32 v219, v17, v11
  s_waitcnt lgkmcnt(0)
  v_lshlrev_b32 v219, 3, v219
  buffer_store_dwordx2 v[180:181], v219, s[12:15], s37 offen
  s_waitcnt vmcnt(0)
L_pskip_0_0:
  s_mov_b64 exec, s[74:75]
  v_cmp_lt_u32 vcc, 63, v45
  s_cbranch_vccz L_pskip_0_1
  s_andn2_b64 s[74:75], s[74:75], vcc
  s_mov_b64 exec, vcc
  ds_add_rtn_u32 v219, v17, v11
  s_waitcnt lgkmcnt(0)
  v_lshlrev_b32 v219, 3, v219
  buffer_store_dwordx2 v[182:183], v219, s[12:15], s37 offen
  s_waitcnt vmcnt(0)
L_pskip_0_1:
  s_mov_b64 exec, s[76:77]
  v_cmp_lt_u32 vcc, 63, v46
  s_cbranch_vccz L_pskip_0_2
  s_andn2_b64 s[76:77], s[76:77], vcc
  s_mov_b64 exec, vcc
  ds_add_rtn_u32 v219, v17, v11
  s_waitcnt lgkmcnt(0)
  v_lshlrev_b32 v219, 3, v219
  buffer_store_dwordx2 v[184:185], v219, s[12:15], s37 offen
  s_waitcnt vmcnt(0)
L_pskip_0_2:
  s_mov_b64 exec, s[78:79]
  v_cmp_lt_u32 vcc, 63, v47
  s_cbranch_vccz L_pskip_0_3
  s_andn2_b64 s[78:79], s[78:79], vcc
  s_mov_b64 exec, vcc
  ds_add_rtn_u32 v219, v17, v11
  s_waitcnt lgkmcnt(0)
  v_lshlrev_b32 v219, 3, v219
  buffer_store_dwordx2 v[186:187], v219, s[12:15], s37 offen
  s_waitcnt vmcnt(0)
L_pskip_0_3:
  s_mov_b64 exec, -1
  s_branch L_pback_0
L_pslow_1:
  s_mov_b64 exec, s[80:81]
  v_cmp_lt_u32 vcc, 63, v48
  s_cbranch_vccz L_pskip_1_4
  s_andn2_b64 s[80:81], s[80:81], vcc
  s_mov_b64 exec, vcc
  ds_add_rtn_u32 v219, v17, v11
  s_waitcnt lgkmcnt(0)
  v_lshlrev_b32 v219, 3, v219
  buffer_store_dwordx2 v[188:189], v219, s[12:15], s37 offen
  s_waitcnt vmcnt(0)
L_pskip_1_4:
  s_mov_b64 exec, s[82:83]
  v_cmp_lt_u32 vcc, 63, v49
  s_cbranch_vccz L_pskip_1_5
  s_andn2_b64 s[82:83], s[82:83], vcc
  s_mov_b64 exec, vcc
  ds_add_rtn_u32 v219, v17, v11
  s_waitcnt lgkmcnt(0)
  v_lshlrev_b32 v219, 3, v219
  buffer_store_dwordx2 v[190:191], v219, s[12:15], s37 offen
  s_waitcnt vmcnt(0)
L_pskip_1_5:
  s_mov_b64 exec, s[84:85]
  v_cmp_lt_u32 vcc, 63, v50
  s_cbranch_vccz L_pskip_1_6
  s_andn2_b64 s[84:85], s[84:85], vcc
  s_mov_b64 exec, vcc
  ds_add_rtn_u32 v219, v17, v11
  s_waitcnt lgkmcnt(0)
  v_lshlrev_b32 v219, 3, v219
  buffer_store_dwordx2 v[192:193], v219, s[12:15], s37 offen
  s_waitcnt vmcnt(0)
L_pskip_1_6:
  s_mov_b64 exec, s[86:87]
  v_cmp_lt_u32 vcc, 63, v51
  s_cbranch_vccz L_pskip_1_7
  s_andn2_b64 s[86:87], s[86:87], vcc
  s_mov_b64 exec, vcc
  ds_add_rtn_u32 v219, v17, v11
  s_waitcnt lgkmcnt(0)
  v_lshlrev_b32 v219, 3, v219
  buffer_store_dwordx2 v[194:195], v219, s[12:15], s37 offen
  s_waitcnt vmcnt(0)
L_pskip_1_7:
  s_mov_b64 exec, -1
  s_branch L_pback_1
L_pslow_2:
  s_mov_b64 exec, s[72:73]
  v_cmp_lt_u32 vcc, 63, v52
  s_cbranch_vccz L_pskip_2_8
  s_andn2_b64 s[72:73], s[72:73], vcc
  s_mov_b64 exec, vcc
  ds_add_rtn_u32 v219, v17, v11
  s_waitcnt lgkmcnt(0)
  v_lshlrev_b32 v219, 3, v219
  buffer_store_dwordx2 v[196:197], v219, s[12:15], s37 offen
  s_waitcnt vmcnt(0)
L_pskip_2_8:
  s_mov_b64 exec, s[74:75]
  v_cmp_lt_u32 vcc, 63, v53
  s_cbranch_vccz L_pskip_2_9
  s_andn2_b64 s[74:75], s[74:75], vcc
  s_mov_b64 exec, vcc
  ds_add_rtn_u32 v219, v17, v11
  s_waitcnt lgkmcnt(0)
  v_lshlrev_b32 v219, 3, v219
  buffer_store_dwordx2 v[198:199], v219, s[12:15], s37 offen
  s_waitcnt vmcnt(0)
L_pskip_2_9:
  s_mov_b64 exec, s[76:77]
  v_cmp_lt_u32 vcc, 63, v54
  s_cbranch_vccz L_pskip_2_10
  s_andn2_b64 s[76:77], s[76:77], vcc
  s_mov_b64 exec, vcc
  ds_add_rtn_u32 v219, v17, v11
  s_waitcnt lgkmcnt(0)
  v_lshlrev_b32 v219, 3, v219
  buffer_store_dwordx2 v[200:201], v219, s[12:15], s37 offen
  s_waitcnt vmcnt(0)
L_pskip_2_10:
  s_mov_b64 exec, s[78:79]
  v_cmp_lt_u32 vcc, 63, v55
  s_cbranch_vccz L_pskip_2_11
  s_andn2_b64 s[78:79], s[78:79], vcc
  s_mov_b64 exec, vcc
  ds_add_rtn_u32 v219, v17, v11
  s_waitcnt lgkmcnt(0)
  v_lshlrev_b32 v219, 3, v219
  buffer_store_dwordx2 v[202:203], v219, s[12:15], s37 offen
  s_waitcnt vmcnt(0)
L_pskip_2_11:
  s_mov_b64 exec, -1
  s_branch L_pback_2
L_pslow_3:
  s_mov_b64 exec, s[80:81]
  v_cmp_lt_u32 vcc, 63, v56
  s_cbranch_vccz L_pskip_3_12
  s_andn2_b64 s[80:81], s[80:81], vcc
  s_mov_b64 exec, vcc
  ds_add_rtn_u32 v219, v17, v11
  s_waitcnt lgkmcnt(0)
  v_lshlrev_b32 v219, 3, v219
  buffer_store_dwordx2 v[204:205], v219, s[12:15], s37 offen
  s_waitcnt vmcnt(0)
L_pskip_3_12:
  s_mov_b64 exec, s[82:83]
  v_cmp_lt_u32 vcc, 63, v57
  s_cbranch_vccz L_pskip_3_13
  s_andn2_b64 s[82:83], s[82:83], vcc
  s_mov_b64 exec, vcc
  ds_add_rtn_u32 v219, v17, v11
  s_waitcnt lgkmcnt(0)
  v_lshlrev_b32 v219, 3, v219
  buffer_store_dwordx2 v[206:207], v219, s[12:15], s37 offen
  s_waitcnt vmcnt(0)
L_pskip_3_13:
  s_mov_b64 exec, s[84:85]
  v_cmp_lt_u32 vcc, 63, v58
  s_cbranch_vccz L_pskip_3_14
  s_andn2_b64 s[84:85], s[84:85], vcc
  s_mov_b64 exec, vcc
  ds_add_rtn_u32 v219, v17, v11
  s_waitcnt lgkmcnt(0)
  v_lshlrev_b32 v219, 3, v219
  buffer_store_dwordx2 v[208:209], v219, s[12:15], s37 offen
  s_waitcnt vmcnt(0)
L_pskip_3_14:
  s_mov_b64 exec, s[86:87]
  v_cmp_lt_u32 vcc, 63, v59
  s_cbranch_vccz L_pskip_3_15
  s_andn2_b64 s[86:87], s[86:87], vcc
  s_mov_b64 exec, vcc
  ds_add_rtn_u32 v219, v17, v11
  s_waitcnt lgkmcnt(0)
  v_lshlrev_b32 v219, 3, v219
  buffer_store_dwordx2 v[210:211], v219, s[12:15], s37 offen
  s_waitcnt vmcnt(0)
L_pskip_3_15:
  s_mov_b64 exec, -1
  s_branch L_pback_3
L_slow_lp:
  s_mov_b32 s41, 512
L_slow_loop_lp:
  v_add_u32 v219, s41, v14
  v_cmp_gt_u32 vcc, s40, v219
  v_lshlrev_b32 v219, 3, v219
  s_nop 0
  v_cndmask_b32 v219, v12, v219, vcc
  buffer_load_dwordx2 v[190:191], v219, s[12:15], s38 offen sc1
  s_waitcnt vmcnt(0)
  v_cmp_gt_i32 vcc, 0, v190
  v_min_i32 v187, v190, v191
  v_cmp_gt_i32 s[72:73], 0, v187
  v_bfe_u32 v228, v187, 23, 8
  v_cndmask_b32_sdwa v186, v190, v191, vcc dst_sel:WORD_1 dst_unused:UNUSED_PAD src0_sel:WORD_1 src1_sel:WORD_0
  v_mad_u32_u24 v228, v228, v15, s36
  s_mov_b64 exec, s[72:73]
  ds_add_rtn_u32 v230, v228, v11
  s_mov_b64 exec, -1
  s_waitcnt lgkmcnt(0)
  s_mov_b64 exec, s[72:73]
  v_cmp_lt_u32 vcc, 31, v230
  v_lshl_add_u32 v228, v230, 3, v228
  s_cbranch_vccnz L_rare_sllp_16
L_back_sllp_16:
  ds_write_b64 v228, v[186:187] offset:8
  s_mov_b64 exec, -1
  s_add_u32 s41, s41, 512
  s_cmp_lt_u32 s41, s40
  s_cbranch_scc1 L_slow_loop_lp
  s_waitcnt vmcnt(0)
  s_branch L_slow_back_lp
L_rare_lp_0:
  s_mov_b64 exec, vcc
  ds_add_rtn_u32 v230, v17, v11
  s_mov_b32 s83, 1
  s_waitcnt lgkmcnt(0)
  v_lshlrev_b32 v230, 3, v230
  buffer_store_dwordx2 v[186:187], v230, s[12:15], s37 offen
  s_andn2_b64 exec, s[72:73], vcc
  s_branch L_back_lp_0
L_rare_lp_1:
  s_mov_b64 exec, vcc
  ds_add_rtn_u32 v231, v17, v11
  s_mov_b32 s83, 1
  s_waitcnt lgkmcnt(0)
  v_lshlrev_b32 v231, 3, v231
  buffer_store_dwordx2 v[188:189], v231, s[12:15], s37 offen
  s_andn2_b64 exec, s[74:75], vcc
  s_branch L_back_lp_1
L_rare_lp_2:
  s_mov_b64 exec, vcc
  ds_add_rtn_u32 v230, v17, v11
  s_mov_b32 s83, 1
  s_waitcnt lgkmcnt(0)
  v_lshlrev_b32 v230, 3, v230
  buffer_store_dwordx2 v[186:187], v230, s[12:15], s37 offen
  s_andn2_b64 exec, s[72:73], vcc
  s_branch L_back_lp_2
L_rare_lp_3:
  s_mov_b64 exec, vcc
  ds_add_rtn_u32 v231, v17, v11
  s_mov_b32 s83, 1
  s_waitcnt lgkmcnt(0)
  v_lshlrev_b32 v231, 3, v231
  buffer_store_dwordx2 v[188:189], v231, s[12:15], s37 offen
  s_andn2_b64 exec, s[74:75], vcc
  s_branch L_back_lp_3
L_rare_lp_4:
  s_mov_b64 exec, vcc
  ds_add_rtn_u32 v230, v17, v11
  s_mov_b32 s83, 1
  s_waitcnt lgkmcnt(0)
  v_lshlrev_b32 v230, 3, v230
  buffer_store_dwordx2 v[186:187], v230, s[12:15], s37 offen
  s_andn2_b64 exec, s[72:73], vcc
  s_branch L_back_lp_4
L_rare_lp_5:
  s_mov_b64 exec, vcc
  ds_add_rtn_u32 v231, v17, v11
  s_mov_b32 s83, 1
  s_waitcnt lgkmcnt(0)
  v_lshlrev_b32 v231, 3, v231
  buffer_store_dwordx2 v[188:189], v231, s[12:15], s37 offen
  s_andn2_b64 exec, s[74:75], vcc
  s_branch L_back_lp_5
L_rare_lp_6:
  s_mov_b64 exec, vcc
  ds_add_rtn_u32 v230, v17, v11
  s_mov_b32 s83, 1
  s_waitcnt lgkmcnt(0)
  v_lshlrev_b32 v230, 3, v230
  buffer_store_dwordx2 v[186:187], v230, s[12:15], s37 offen
  s_andn2_b64 exec, s[72:73], vcc
  s_branch L_back_lp_6
L_rare_lp_7:
  s_mov_b64 exec, vcc
  ds_add_rtn_u32 v231, v17, v11
  s_mov_b32 s83, 1
  s_waitcnt lgkmcnt(0)
  v_lshlrev_b32 v231, 3, v231
  buffer_store_dwordx2 v[188:189], v231, s[12:15], s37 offen
  s_andn2_b64 exec, s[74:75], vcc
  s_branch L_back_lp_7
L_rare_lp_8:
  s_mov_b64 exec, vcc
  ds_add_rtn_u32 v230, v17, v11
  s_mov_b32 s83, 1
  s_waitcnt lgkmcnt(0)
  v_lshlrev_b32 v230, 3, v230
  buffer_store_dwordx2 v[186:187], v230, s[12:15], s37 offen
  s_andn2_b64 exec, s[72:73], vcc
  s_branch L_back_lp_8
L_rare_lp_9:
  s_mov_b64 exec, vcc
  ds_add_rtn_u32 v231, v17, v11
  s_mov_b32 s83, 1
  s_waitcnt lgkmcnt(0)
  v_lshlrev_b32 v231, 3, v231
  buffer_store_dwordx2 v[188:189], v231, s[12:15], s37 offen
  s_andn2_b64 exec, s[74:75], vcc
  s_branch L_back_lp_9
L_rare_lp_10:
  s_mov_b64 exec, vcc
  ds_add_rtn_u32 v230, v17, v11
  s_mov_b32 s83, 1
  s_waitcnt lgkmcnt(0)
  v_lshlrev_b32 v230, 3, v230
  buffer_store_dwordx2 v[186:187], v230, s[12:15], s37 offen
  s_andn2_b64 exec, s[72:73], vcc
  s_branch L_back_lp_10
L_rare_lp_11:
  s_mov_b64 exec, vcc
  ds_add_rtn_u32 v231, v17, v11
  s_mov_b32 s83, 1
  s_waitcnt lgkmcnt(0)
  v_lshlrev_b32 v231, 3, v231
  buffer_store_dwordx2 v[188:189], v231, s[12:15], s37 offen
  s_andn2_b64 exec, s[74:75], vcc
  s_branch L_back_lp_11
L_rare_lp_12:
  s_mov_b64 exec, vcc
  ds_add_rtn_u32 v230, v17, v11
  s_mov_b32 s83, 1
  s_waitcnt lgkmcnt(0)
  v_lshlrev_b32 v230, 3, v230
  buffer_store_dwordx2 v[186:187], v230, s[12:15], s37 offen
  s_andn2_b64 exec, s[72:73], vcc
  s_branch L_back_lp_12
L_rare_lp_13:
  s_mov_b64 exec, vcc
  ds_add_rtn_u32 v231, v17, v11
  s_mov_b32 s83, 1
  s_waitcnt lgkmcnt(0)
  v_lshlrev_b32 v231, 3, v231
  buffer_store_dwordx2 v[188:189], v231, s[12:15], s37 offen
  s_andn2_b64 exec, s[74:75], vcc
  s_branch L_back_lp_13
L_rare_lp_14:
  s_mov_b64 exec, vcc
  ds_add_rtn_u32 v230, v17, v11
  s_mov_b32 s83, 1
  s_waitcnt lgkmcnt(0)
  v_lshlrev_b32 v230, 3, v230
  buffer_store_dwordx2 v[186:187], v230, s[12:15], s37 offen
  s_andn2_b64 exec, s[72:73], vcc
  s_branch L_back_lp_14
L_rare_lp_15:
  s_mov_b64 exec, vcc
  ds_add_rtn_u32 v231, v17, v11
  s_mov_b32 s83, 1
  s_waitcnt lgkmcnt(0)
  v_lshlrev_b32 v231, 3, v231
  buffer_store_dwordx2 v[188:189], v231, s[12:15], s37 offen
  s_andn2_b64 exec, s[74:75], vcc
  s_branch L_back_lp_15
L_rare_lp_16:
  s_mov_b64 exec, vcc
  ds_add_rtn_u32 v230, v17, v11
  s_mov_b32 s83, 1
  s_waitcnt lgkmcnt(0)
  v_lshlrev_b32 v230, 3, v230
  buffer_store_dwordx2 v[186:187], v230, s[12:15], s37 offen
  s_andn2_b64 exec, s[72:73], vcc
  s_branch L_back_lp_16
L_rare_sllp_16:
  s_mov_b64 exec, vcc
  ds_add_rtn_u32 v230, v17, v11
  s_mov_b32 s83, 1
  s_waitcnt lgkmcnt(0)
  v_lshlrev_b32 v230, 3, v230
  buffer_store_dwordx2 v[186:187], v230, s[12:15], s37 offen
  s_andn2_b64 exec, s[72:73], vcc
  s_branch L_back_sllp_16
L_code_end:
.section .rodata,"a"
.p2align 6
.amdhsa_kernel gather_scatter__molecular_angular_gemnet__graph_kernel
  .amdhsa_next_free_vgpr 256
  .amdhsa_next_free_sgpr 102
  .amdhsa_accum_offset 256
  .amdhsa_group_segment_fixed_size 0
  .amdhsa_kernarg_size 112
  .amdhsa_user_sgpr_count 2
  .amdhsa_user_sgpr_kernarg_segment_ptr 1
  .amdhsa_system_sgpr_workgroup_id_x 1
  .amdhsa_float_denorm_mode_32 3
.end_amdhsa_kernel
```
